```python
import torch

def _softmax(x, axis=-1):
    return torch.softmax(x, dim=axis)
def _gelu(x):
    return torch.nn.functional.gelu(x, approximate="tanh")
def _silu(x):
    return torch.nn.functional.silu(x)
def _sigmoid(x):
    return torch.sigmoid(x)
def _layernorm(x, axis=-1, eps=1e-5):
    m = x.mean(dim=axis, keepdim=True)
    v = x.var(dim=axis, keepdim=True, unbiased=False)
    return (x - m) / torch.sqrt(v + eps)
def _scatter_add(tgt, idx, src, axis=0):
    return tgt.clone().index_add_(axis, idx, src)
def _segment_sum(src, seg, n):
    out = torch.zeros((n,) + src.shape[1:], dtype=src.dtype)
    return out.index_add_(0, seg, src)
def _pad(x, pw):
    flat = tuple(v for pair in reversed(pw) for v in pair)
    return torch.nn.functional.pad(x, flat)

kernel_name = 'standalone__batchnorm__sampling'

def setup_inputs():

    _w = (lambda a: (lambda t: t.to(torch.bfloat16) if t.is_floating_point() else t)(torch.as_tensor(a)))
    B, S, C = 1024, 16, 512
    K = 3
    return {
        "x": _w((lambda *s: torch.randn(*s, dtype=torch.bfloat16) * 0.05)(B, S, C)),
        "w": _w((lambda *s: torch.randn(*s, dtype=torch.bfloat16) * 0.05)(K, C, C) * (1.0 / (K * C) ** 0.5)),
        "mean": _w((lambda *s: torch.randn(*s, dtype=torch.bfloat16) * 0.05)(C) * 0.1),
        "var": _w(torch.abs((lambda *s: torch.randn(*s, dtype=torch.bfloat16) * 0.05)(C)) + 0.5),
        "g": _w((lambda *s: torch.randn(*s, dtype=torch.bfloat16) * 0.05)(C) + 1.0),
        "b": _w((lambda *s: torch.randn(*s, dtype=torch.bfloat16) * 0.05)(C) * 0.1),
    }

def reference(x, w, mean, var, g, b):
    K = 3
    P = K // 2
    S = x.shape[1]
    xp = _pad(x, ((0, 0), (P, P), (0, 0)))
    y = sum(torch.einsum('bsc,cd->bsd', xp[:, k:k + S, :], w[k]) for k in range(K))
    inv_std = 1.0 / torch.sqrt(var + 1e-5)
    y = (y - mean) * (g * inv_std) + b
    return _silu(y)
```

```asm
; @launch grid=(256,1,1) block=(256,1,1) lds=163840
.amdgcn_target "amdgcn-amd-amdhsa--gfx950"
.text
.globl standalone__batchnorm__sampling_kernel
.p2align 12
.p2align 8
.type standalone__batchnorm__sampling_kernel,@function
standalone__batchnorm__sampling_kernel:
    s_load_dwordx4 s[28:31], s[0:1], 0
    s_load_dwordx8 s[64:71], s[0:1], 16
    s_load_dwordx2 s[72:73], s[0:1], 48
    s_cmp_ge_u32 s2, 256
    s_cbranch_scc1 L_end
    v_lshrrev_b32 v56, 6, v0
    v_and_b32 v0, 63, v0
    v_readfirstlane_b32 s3, v56
    s_and_b32 s4, s2, 7
    s_lshr_b32 s5, s2, 3
    s_and_b32 s6, s5, 3
    s_lshr_b32 s33, s5, 2
    s_lshl_b32 s7, s4, 3
    s_add_u32 s7, s7, s33
    s_lshl_b32 s7, s7, 18
    s_lshl_b32 s6, s6, 8
    s_lshl_b32 s59, s4, 16
    s_lshl_b32 s58, s4, 7
    v_lshrrev_b32 v56, 4, v0
    v_and_b32 v57, 15, v0
    v_and_b32 v58, 1, v56
    v_lshlrev_b32 v58, 2, v58
    v_or_b32 v58, s3, v58
    v_lshlrev_b32 v58, 1, v58
    v_xor_b32 v58, v58, v57
    v_lshlrev_b32 v58, 4, v58
    v_lshl_add_u32 v58, v56, 13, v58
    s_lshl_b32 s33, s3, 10
    s_add_u32 s34, s33, s6
    v_add_u32 v7, s34, v58
    s_add_u32 s60, s33, 65536
    s_and_b32 s35, s3, 1
    s_lshr_b32 s36, s3, 1
    v_lshrrev_b32 v59, 3, v0
    v_and_b32 v60, 7, v0
    v_lshrrev_b32 v61, 1, v59
    s_lshl_b32 s37, s35, 2
    v_add_u32 v61, s37, v61
    v_xor_b32 v61, v61, v60
    v_lshlrev_b32 v61, 4, v61
    v_lshl_add_u32 v61, v59, 14, v61
    s_lshl_b32 s37, s35, 17
    s_add_u32 s37, s37, s7
    s_lshl_b32 s38, s36, 10
    s_add_u32 s39, s37, s38
    v_add_u32 v8, s39, v61
    s_lshl_b32 s61, s35, 13
    s_add_u32 s61, s61, s38
    s_mov_b32 s10, 0x1000000
    s_mov_b32 s11, 0x20000
    s_mov_b32 s14, 0x180000
    s_mov_b32 s15, 0x20000
    s_getpc_b64 s[56:57]
    s_lshl_b32 s39, s5, 2
    s_add_u32 s39, s39, s3
    s_lshl_b32 s39, s39, 8
    v_and_b32 v39, 1, v0
    v_lshl_add_u32 v39, v39, 7, s39
    s_mov_b32 s32, 65536
    v_lshrrev_b32 v58, 1, v57
    v_xor_b32 v58, v58, v56
    v_lshlrev_b32 v58, 4, v58
    v_and_b32 v59, 7, v57
    v_lshl_add_u32 v58, v59, 7, v58
    v_lshrrev_b32 v59, 3, v57
    v_lshl_add_u32 v1, v59, 13, v58
    v_xor_b32 v2, 64, v1
    v_mul_u32_u24 v59, 6144, v59
    v_add3_u32 v12, v59, v58, s32
    v_xor_b32 v13, 64, v12
    v_add_u32 v14, 61440, v12
    v_add_u32 v15, 61440, v13
    s_mul_i32 s32, s35, 6144
    s_add_u32 s32, s32, s38
    v_lshrrev_b32 v58, 2, v57
    v_and_b32 v59, 3, v0
    v_and_b32 v62, 1, v56
    v_lshl_add_u32 v62, v62, 2, v58
    v_lshlrev_b32 v62, 1, v62
    s_lshl_b32 s34, s3, 2
    v_add_u32 v63, s34, v59
    v_xor_b32 v63, v63, v62
    v_lshlrev_b32 v63, 4, v63
    v_lshl_add_u32 v63, v58, 10, v63
    v_lshl_add_u32 v63, v56, 8, v63
    v_add_u32 v3, 65536, v63
    v_xor_b32 v4, 8, v3
    v_add_u32 v5, 49152, v3
    v_add_u32 v6, 49152, v4
    s_lshl_b32 s33, s3, 6
    v_lshl_add_u32 v37, v56, 4, s33
    s_add_u32 s33, s6, s7
    v_lshl_add_u32 v58, v57, 14, v37
    v_add_u32 v10, s33, v58
    s_mov_b32 s18, 0x1000000
    s_mov_b32 s19, 0x20000
    s_mov_b32 s34, 0xbfb8aa3b
    s_mov_b32 s35, s34
    s_mov_b32 s36, 4096
    s_mov_b32 s37, 8192
    s_mov_b32 s38, 12288
    s_mov_b32 s22, 1024
    s_mov_b32 s23, 0x20000
    v_lshlrev_b32 v11, 2, v0
    s_lshl_b32 s39, s3, 8
    s_waitcnt lgkmcnt(0)
    s_mov_b32 s8, s28
    s_and_b32 s9, s29, 0xffff
    s_mov_b32 s12, s30
    s_and_b32 s13, s31, 0xffff
    s_add_u32 m0, s60, 0
    s_xor_b32 s53, s59, 0
    buffer_load_dwordx4 v7, s[12:15], s53 offen lds
    s_add_u32 m0, s60, 4096
    s_xor_b32 s54, s59, 4096
    buffer_load_dwordx4 v7, s[12:15], s54 offen lds
    s_add_u32 m0, s60, 8192
    s_xor_b32 s55, s59, 524288
    buffer_load_dwordx4 v7, s[12:15], s55 offen lds
    s_add_u32 m0, s60, 12288
    s_xor_b32 s52, s59, 528384
    buffer_load_dwordx4 v7, s[12:15], s52 offen lds
    s_add_u32 m0, s60, 16384
    s_xor_b32 s53, s59, 1048576
    buffer_load_dwordx4 v7, s[12:15], s53 offen lds
    s_add_u32 m0, s60, 20480
    s_xor_b32 s54, s59, 1052672
    buffer_load_dwordx4 v7, s[12:15], s54 offen lds
    s_add_u32 m0, s61, 0
    s_xor_b32 s55, s58, 0
    buffer_load_dwordx4 v8, s[8:11], s55 offen offset:0 nt lds
    buffer_load_dwordx4 v8, s[8:11], s55 offen offset:2048 nt lds
    global_load_dword v38, v39, s[56:57]
    s_add_u32 m0, s61, 4096
    s_xor_b32 s52, s58, 4096
    buffer_load_dwordx4 v8, s[8:11], s52 offen offset:0 nt lds
    buffer_load_dwordx4 v8, s[8:11], s52 offen offset:2048 nt lds
    s_mov_b32 s16, s72
    s_and_b32 s17, s73, 0xffff
    s_cmp_eq_u32 s3, 1
    s_cselect_b64 s[64:65], s[66:67], s[64:65]
    s_cmp_eq_u32 s3, 2
    s_cselect_b64 s[64:65], s[68:69], s[64:65]
    s_cmp_eq_u32 s3, 3
    s_cselect_b64 s[64:65], s[70:71], s[64:65]
    s_mov_b32 s20, s64
    s_and_b32 s21, s65, 0xffff
    s_mov_b64 vcc, 1
    s_cmp_eq_u32 s3, 0
    s_cbranch_scc1 L_stub0
    s_cmp_eq_u32 s3, 1
    s_cbranch_scc1 L_stub1
    s_cmp_eq_u32 s3, 2
    s_cbranch_scc1 L_stub2
    s_cmp_eq_u32 s3, 3
    s_cbranch_scc1 L_stub3
L_back0:
    s_mov_b64 vcc, 0
    s_add_u32 m0, s61, 16384
    s_xor_b32 s53, s58, 8192
    buffer_load_dwordx4 v8, s[8:11], s53 offen offset:0 nt lds
    buffer_load_dwordx4 v8, s[8:11], s53 offen offset:2048 nt lds
    s_add_u32 m0, s61, 20480
    s_xor_b32 s54, s58, 12288
    buffer_load_dwordx4 v8, s[8:11], s54 offen offset:0 nt lds
    buffer_load_dwordx4 v8, s[8:11], s54 offen offset:2048 nt lds
    s_add_u32 m0, s39, 49152
    s_nop 0
    buffer_load_dword v11, s[20:23], s6 offen lds
    s_add_u32 m0, s60, 24576
    s_xor_b32 s55, s59, 32768
    buffer_load_dwordx4 v7, s[12:15], s55 offen lds
    s_add_u32 m0, s60, 28672
    s_xor_b32 s52, s59, 36864
    buffer_load_dwordx4 v7, s[12:15], s52 offen lds
    s_mov_b64 vcc, 1
    s_cmp_eq_u32 s3, 0
    s_cbranch_scc1 L_stub4
    s_cmp_eq_u32 s3, 1
    s_cbranch_scc1 L_stub5
L_back1:
    s_mov_b64 vcc, 0
    s_waitcnt vmcnt(10)
    s_barrier
    ds_read_b128 v[96:99], v1 offset:0
    ds_read_b64_tr_b16 a[8:9], v3 offset:8192
    ds_read_b64_tr_b16 a[10:11], v3 offset:12288
    ds_read_b128 v[100:103], v1 offset:1024
    ds_read_b64_tr_b16 a[16:17], v3 offset:16384
    ds_read_b64_tr_b16 a[18:19], v3 offset:20480
    ds_read_b64_tr_b16 a[20:21], v4 offset:16384
    ds_read_b64_tr_b16 a[22:23], v4 offset:20480
    ds_read_b64_tr_b16 a[12:13], v4 offset:8192
    ds_read_b64_tr_b16 a[14:15], v4 offset:12288
    ds_read_b128 v[104:107], v1 offset:2048
    ds_read_b64_tr_b16 a[4:5], v4 offset:0
    ds_read_b64_tr_b16 a[6:7], v4 offset:4096
    ds_read_b64_tr_b16 a[0:1], v3 offset:0
    ds_read_b64_tr_b16 a[2:3], v3 offset:4096
    s_waitcnt lgkmcnt(12)
    v_mfma_f32_16x16x32_bf16 v[128:131], a[8:11], v[96:99], 0
    s_waitcnt lgkmcnt(9)
    s_add_u32 m0, s60, 32768
    ds_read_b128 v[108:111], v1 offset:3072
    v_mfma_f32_16x16x32_bf16 v[128:131], a[16:19], v[100:103], v[128:131]
    s_waitcnt lgkmcnt(8)
    s_xor_b32 s53, s59, 557056
    v_mfma_f32_16x16x32_bf16 v[132:135], a[20:23], v[100:103], 0
    s_waitcnt lgkmcnt(6)
    v_mfma_f32_16x16x32_bf16 v[132:135], a[12:15], v[96:99], v[132:135]
    s_waitcnt lgkmcnt(3)
    v_mfma_f32_16x16x32_bf16 v[140:143], a[4:7], v[96:99], 0
    buffer_load_dwordx4 v7, s[12:15], s53 offen lds
    v_mfma_f32_16x16x32_bf16 v[140:143], a[12:15], v[100:103], v[140:143]
    s_add_u32 m0, s60, 36864
    s_xor_b32 s54, s59, 561152
    v_mfma_f32_16x16x32_bf16 v[140:143], a[20:23], v[104:107], v[140:143]
    v_mfma_f32_16x16x32_bf16 v[136:139], a[16:19], v[104:107], 0
    s_waitcnt vmcnt(8)
    v_mfma_f32_16x16x32_bf16 v[136:139], a[8:11], v[100:103], v[136:139]
    s_barrier
    s_waitcnt lgkmcnt(1)
    ds_read_b128 v[112:115], v1 offset:4096
    v_mfma_f32_16x16x32_bf16 v[136:139], a[0:3], v[96:99], v[136:139]
    buffer_load_dwordx4 v7, s[12:15], s54 offen lds
    v_mfma_f32_16x16x32_bf16 v[144:147], a[0:3], v[100:103], 0
    s_add_u32 m0, s60, 40960
    s_xor_b32 s55, s59, 1081344
    ds_read_b128 v[116:119], v1 offset:5120
    v_mfma_f32_16x16x32_bf16 v[144:147], a[8:11], v[104:107], v[144:147]
    s_waitcnt lgkmcnt(2)
    v_mfma_f32_16x16x32_bf16 v[144:147], a[16:19], v[108:111], v[144:147]
    buffer_load_dwordx4 v7, s[12:15], s55 offen lds
    v_mfma_f32_16x16x32_bf16 v[148:151], a[20:23], v[108:111], 0
    s_add_u32 m0, s60, 45056
    s_xor_b32 s52, s59, 1085440
    v_mfma_f32_16x16x32_bf16 v[148:151], a[12:15], v[104:107], v[148:151]
    ds_read_b128 v[120:123], v1 offset:6144
    v_mfma_f32_16x16x32_bf16 v[148:151], a[4:7], v[100:103], v[148:151]
    v_mfma_f32_16x16x32_bf16 v[156:159], a[4:7], v[104:107], 0
    buffer_load_dwordx4 v7, s[12:15], s52 offen lds
    v_mfma_f32_16x16x32_bf16 v[156:159], a[12:15], v[108:111], v[156:159]
    s_waitcnt lgkmcnt(2)
    s_add_u32 m0, s61, 32768
    s_xor_b32 s53, s58, 128
    v_mfma_f32_16x16x32_bf16 v[156:159], a[20:23], v[112:115], v[156:159]
    v_mfma_f32_16x16x32_bf16 v[152:155], a[16:19], v[112:115], 0
    v_mfma_f32_16x16x32_bf16 v[152:155], a[8:11], v[108:111], v[152:155]
    buffer_load_dwordx4 v8, s[8:11], s53 offen offset:0 nt lds
    v_mfma_f32_16x16x32_bf16 v[152:155], a[0:3], v[104:107], v[152:155]
    ds_read_b128 v[124:127], v1 offset:7168
    v_mfma_f32_16x16x32_bf16 v[160:163], a[0:3], v[108:111], 0
    v_mfma_f32_16x16x32_bf16 v[160:163], a[8:11], v[112:115], v[160:163]
    s_waitcnt lgkmcnt(2)
    v_mfma_f32_16x16x32_bf16 v[160:163], a[16:19], v[116:119], v[160:163]
    buffer_load_dwordx4 v8, s[8:11], s53 offen offset:2048 nt lds
    v_mfma_f32_16x16x32_bf16 v[164:167], a[20:23], v[116:119], 0
    s_add_u32 m0, s61, 36864
    s_xor_b32 s54, s58, 4224
    v_mfma_f32_16x16x32_bf16 v[164:167], a[12:15], v[112:115], v[164:167]
    v_mfma_f32_16x16x32_bf16 v[164:167], a[4:7], v[108:111], v[164:167]
    v_mfma_f32_16x16x32_bf16 v[172:175], a[4:7], v[112:115], 0
    buffer_load_dwordx4 v8, s[8:11], s54 offen offset:0 nt lds
    v_mfma_f32_16x16x32_bf16 v[172:175], a[12:15], v[116:119], v[172:175]
    s_waitcnt lgkmcnt(1)
    v_mfma_f32_16x16x32_bf16 v[172:175], a[20:23], v[120:123], v[172:175]
    v_mfma_f32_16x16x32_bf16 v[168:171], a[16:19], v[120:123], 0
    s_waitcnt vmcnt(12)
    v_mfma_f32_16x16x32_bf16 v[168:171], a[8:11], v[116:119], v[168:171]
    s_barrier
    ds_read_b128 v[96:99], v1 offset:16384
    v_mfma_f32_16x16x32_bf16 v[168:171], a[0:3], v[112:115], v[168:171]
    buffer_load_dwordx4 v8, s[8:11], s54 offen offset:2048 nt lds
    v_mfma_f32_16x16x32_bf16 v[176:179], a[0:3], v[116:119], 0
    s_add_u32 m0, s60, 49152
    s_xor_b32 s55, s59, 65536
    ds_read_b128 v[100:103], v1 offset:17408
    v_mfma_f32_16x16x32_bf16 v[176:179], a[8:11], v[120:123], v[176:179]
    s_waitcnt lgkmcnt(2)
    v_mfma_f32_16x16x32_bf16 v[176:179], a[16:19], v[124:127], v[176:179]
    buffer_load_dwordx4 v7, s[12:15], s55 offen lds
    v_mfma_f32_16x16x32_bf16 v[180:183], a[20:23], v[124:127], 0
    s_add_u32 m0, s60, 53248
    s_xor_b32 s52, s59, 69632
    v_mfma_f32_16x16x32_bf16 v[180:183], a[12:15], v[120:123], v[180:183]
    ds_read_b128 v[104:107], v1 offset:18432
    v_mfma_f32_16x16x32_bf16 v[180:183], a[4:7], v[116:119], v[180:183]
    v_mfma_f32_16x16x32_bf16 v[188:191], a[4:7], v[120:123], 0
    buffer_load_dwordx4 v7, s[12:15], s52 offen lds
    v_mfma_f32_16x16x32_bf16 v[188:191], a[12:15], v[124:127], v[188:191]
    s_waitcnt lgkmcnt(2)
    s_add_u32 m0, s60, 57344
    s_xor_b32 s53, s59, 589824
    v_mfma_f32_16x16x32_bf16 v[188:191], a[20:23], v[96:99], v[188:191]
    v_mfma_f32_16x16x32_bf16 v[184:187], a[16:19], v[96:99], 0
    v_mfma_f32_16x16x32_bf16 v[184:187], a[8:11], v[124:127], v[184:187]
    buffer_load_dwordx4 v7, s[12:15], s53 offen lds
    v_mfma_f32_16x16x32_bf16 v[184:187], a[0:3], v[120:123], v[184:187]
    s_add_u32 m0, s60, 61440
    s_xor_b32 s54, s59, 593920
    ds_read_b128 v[108:111], v1 offset:19456
    v_mfma_f32_16x16x32_bf16 v[192:195], a[0:3], v[124:127], 0
    v_mfma_f32_16x16x32_bf16 v[192:195], a[8:11], v[96:99], v[192:195]
    s_waitcnt lgkmcnt(2)
    v_mfma_f32_16x16x32_bf16 v[192:195], a[16:19], v[100:103], v[192:195]
    buffer_load_dwordx4 v7, s[12:15], s54 offen lds
    v_mfma_f32_16x16x32_bf16 v[196:199], a[20:23], v[100:103], 0
    s_add_u32 m0, s60, 65536
    s_xor_b32 s55, s59, 1114112
    v_mfma_f32_16x16x32_bf16 v[196:199], a[12:15], v[96:99], v[196:199]
    v_mfma_f32_16x16x32_bf16 v[196:199], a[4:7], v[124:127], v[196:199]
    v_mfma_f32_16x16x32_bf16 v[204:207], a[4:7], v[96:99], 0
    buffer_load_dwordx4 v7, s[12:15], s55 offen lds
    v_mfma_f32_16x16x32_bf16 v[204:207], a[12:15], v[100:103], v[204:207]
    s_waitcnt lgkmcnt(1)
    s_add_u32 m0, s60, 69632
    s_xor_b32 s52, s59, 1118208
    v_mfma_f32_16x16x32_bf16 v[204:207], a[20:23], v[104:107], v[204:207]
    v_mfma_f32_16x16x32_bf16 v[200:203], a[16:19], v[104:107], 0
    s_waitcnt vmcnt(15)
    v_mfma_f32_16x16x32_bf16 v[200:203], a[8:11], v[100:103], v[200:203]
    s_barrier
    ds_read_b128 v[112:115], v1 offset:20480
    v_mfma_f32_16x16x32_bf16 v[200:203], a[0:3], v[96:99], v[200:203]
    buffer_load_dwordx4 v7, s[12:15], s52 offen lds
    v_mfma_f32_16x16x32_bf16 v[208:211], a[0:3], v[100:103], 0
    ds_read_b128 v[116:119], v1 offset:21504
    v_mfma_f32_16x16x32_bf16 v[208:211], a[8:11], v[104:107], v[208:211]
    s_waitcnt lgkmcnt(2)
    ds_read_b128 v[16:19], v37 offset:49152
    v_mfma_f32_16x16x32_bf16 v[208:211], a[16:19], v[108:111], v[208:211]
    ds_read_b128 v[20:23], v37 offset:49408
    v_mfma_f32_16x16x32_bf16 v[212:215], a[20:23], v[108:111], 0
    ds_read_b128 v[24:27], v37 offset:49664
    v_mfma_f32_16x16x32_bf16 v[212:215], a[12:15], v[104:107], v[212:215]
    ds_read_b128 v[28:31], v37 offset:49920
    v_mfma_f32_16x16x32_bf16 v[212:215], a[4:7], v[100:103], v[212:215]
    ds_read_b128 v[120:123], v1 offset:22528
    v_mfma_f32_16x16x32_bf16 v[220:223], a[4:7], v[104:107], 0
    v_mfma_f32_16x16x32_bf16 v[220:223], a[12:15], v[108:111], v[220:223]
    s_waitcnt lgkmcnt(6)
    v_mfma_f32_16x16x32_bf16 v[220:223], a[20:23], v[112:115], v[220:223]
    v_mfma_f32_16x16x32_bf16 v[216:219], a[16:19], v[112:115], 0
    v_mfma_f32_16x16x32_bf16 v[216:219], a[8:11], v[108:111], v[216:219]
    ds_read_b128 v[124:127], v1 offset:23552
    v_mfma_f32_16x16x32_bf16 v[216:219], a[0:3], v[104:107], v[216:219]
    v_mfma_f32_16x16x32_bf16 v[224:227], a[0:3], v[108:111], 0
    v_mfma_f32_16x16x32_bf16 v[224:227], a[8:11], v[112:115], v[224:227]
    s_waitcnt lgkmcnt(6)
    v_mfma_f32_16x16x32_bf16 v[224:227], a[16:19], v[116:119], v[224:227]
    v_mfma_f32_16x16x32_bf16 v[228:231], a[20:23], v[116:119], 0
    v_mfma_f32_16x16x32_bf16 v[228:231], a[12:15], v[112:115], v[228:231]
    s_waitcnt vmcnt(10) lgkmcnt(2)
    v_mfma_f32_16x16x32_bf16 v[228:231], a[4:7], v[108:111], v[228:231]
    s_barrier
    ds_read_b64_tr_b16 a[32:33], v3 offset:32768
    v_lshlrev_b32 v56, 16, v20
    v_mfma_f32_16x16x32_bf16 v[236:239], a[4:7], v[112:115], 0
    s_add_u32 m0, s60, 73728
    ds_read_b64_tr_b16 a[34:35], v3 offset:36864
    v_lshlrev_b32 v57, 16, v24
    v_mfma_f32_16x16x32_bf16 v[236:239], a[12:15], v[116:119], v[236:239]
    s_waitcnt lgkmcnt(3)
    ds_read_b128 v[96:99], v2 offset:0
    v_lshlrev_b32 v58, 16, v16
    v_mfma_f32_16x16x32_bf16 v[236:239], a[20:23], v[120:123], v[236:239]
    s_xor_b32 s53, s59, 98304
    ds_read_b64_tr_b16 a[40:41], v3 offset:40960
    v_lshlrev_b32 v59, 16, v28
    v_mfma_f32_16x16x32_bf16 v[232:235], a[16:19], v[120:123], 0
    buffer_load_dwordx4 v7, s[12:15], s53 offen lds
    v_mfma_f32_16x16x32_bf16 v[232:235], a[8:11], v[116:119], v[232:235]
    s_add_u32 m0, s60, 77824
    ds_read_b64_tr_b16 a[42:43], v3 offset:45056
    v_add_f32 v56, 0x3727c5ac, v56
    v_mfma_f32_16x16x32_bf16 v[232:235], a[0:3], v[112:115], v[232:235]
    s_xor_b32 s54, s59, 102400
    ds_read_b128 v[100:103], v2 offset:1024
    v_mfma_f32_16x16x32_bf16 v[240:243], a[0:3], v[116:119], 0
    ds_read_b64_tr_b16 a[44:45], v4 offset:40960
    v_mfma_f32_16x16x32_bf16 v[240:243], a[8:11], v[120:123], v[240:243]
    s_waitcnt lgkmcnt(7)
    ds_read_b64_tr_b16 a[46:47], v4 offset:45056
    v_mfma_f32_16x16x32_bf16 v[240:243], a[16:19], v[124:127], v[240:243]
    ds_read_b64_tr_b16 a[36:37], v4 offset:32768
    v_mfma_f32_16x16x32_bf16 v[244:247], a[20:23], v[124:127], 0
    buffer_load_dwordx4 v7, s[12:15], s54 offen lds
    v_mfma_f32_16x16x32_bf16 v[244:247], a[12:15], v[120:123], v[244:247]
    s_add_u32 m0, s60, 81920
    ds_read_b64_tr_b16 a[38:39], v4 offset:36864
    v_mfma_f32_16x16x32_bf16 v[244:247], a[4:7], v[116:119], v[244:247]
    s_xor_b32 s55, s59, 622592
    ds_read_b64_tr_b16 a[28:29], v4 offset:24576
    v_mfma_f32_16x16x32_bf16 v[252:255], a[4:7], v[120:123], 0
    ds_read_b64_tr_b16 a[30:31], v4 offset:28672
    v_mfma_f32_16x16x32_bf16 v[252:255], a[12:15], v[124:127], v[252:255]
    ds_read_b128 v[104:107], v2 offset:2048
    v_mfma_f32_16x16x32_bf16 v[248:251], a[8:11], v[124:127], 0
    ds_read_b64_tr_b16 a[24:25], v3 offset:24576
    v_mfma_f32_16x16x32_bf16 v[248:251], a[0:3], v[120:123], v[248:251]
    s_waitcnt lgkmcnt(11)
    ds_read_b64_tr_b16 a[26:27], v3 offset:28672
    v_mfma_f32_16x16x32_bf16 v[128:131], a[32:35], v[96:99], v[128:131]
    s_waitcnt lgkmcnt(9)
    ds_read_b128 v[108:111], v2 offset:3072
    v_mfma_f32_16x16x32_bf16 v[128:131], a[40:43], v[100:103], v[128:131]
    s_waitcnt lgkmcnt(8)
    v_sqrt_f32 v56, v56
    v_mfma_f32_16x16x32_bf16 v[132:135], a[44:47], v[100:103], v[132:135]
    s_waitcnt lgkmcnt(6)
    ds_read_b128 v[112:115], v2 offset:4096
    v_mfma_f32_16x16x32_bf16 v[132:135], a[36:39], v[96:99], v[132:135]
    s_waitcnt lgkmcnt(5)
    v_rcp_f32 v56, v56
    v_mfma_f32_16x16x32_bf16 v[140:143], a[28:31], v[96:99], v[140:143]
    buffer_load_dwordx4 v7, s[12:15], s55 offen lds
    v_mfma_f32_16x16x32_bf16 v[140:143], a[36:39], v[100:103], v[140:143]
    s_waitcnt lgkmcnt(4)
    s_add_u32 m0, s60, 86016
    v_mul_f32 v58, s34, v58
    v_mfma_f32_16x16x32_bf16 v[140:143], a[44:47], v[104:107], v[140:143]
    s_xor_b32 s52, s59, 626688
    v_mul_f32 v56, v57, v56
    v_mul_f32 v59, s34, v59
    v_mfma_f32_16x16x32_bf16 v[136:139], a[40:43], v[104:107], v[136:139]
    v_mul_f32 v40, s34, v56
    v_fma_f32 v48, -v58, v56, v59
    v_mfma_f32_16x16x32_bf16 v[136:139], a[32:35], v[100:103], v[136:139]
    s_waitcnt lgkmcnt(2)
    ds_read_b128 v[116:119], v2 offset:5120
    v_and_b32 v60, 0xffff0000, v20
    v_mfma_f32_16x16x32_bf16 v[136:139], a[24:27], v[96:99], v[136:139]
    v_and_b32 v61, 0xffff0000, v24
    v_and_b32 v62, 0xffff0000, v16
    v_mfma_f32_16x16x32_bf16 v[144:147], a[24:27], v[100:103], v[144:147]
    buffer_load_dwordx4 v7, s[12:15], s52 offen lds
    v_mfma_f32_16x16x32_bf16 v[144:147], a[32:35], v[104:107], v[144:147]
    s_waitcnt lgkmcnt(2)
    s_add_u32 m0, s60, 90112
    v_and_b32 v63, 0xffff0000, v28
    v_mfma_f32_16x16x32_bf16 v[144:147], a[40:43], v[108:111], v[144:147]
    s_xor_b32 s53, s59, 1146880
    v_add_f32 v60, 0x3727c5ac, v60
    v_mfma_f32_16x16x32_bf16 v[148:151], a[44:47], v[108:111], v[148:151]
    v_sqrt_f32 v60, v60
    v_mfma_f32_16x16x32_bf16 v[148:151], a[36:39], v[104:107], v[148:151]
    ds_read_b128 v[120:123], v2 offset:6144
    v_mfma_f32_16x16x32_bf16 v[148:151], a[28:31], v[100:103], v[148:151]
    v_rcp_f32 v60, v60
    v_mfma_f32_16x16x32_bf16 v[156:159], a[28:31], v[104:107], v[156:159]
    buffer_load_dwordx4 v7, s[12:15], s53 offen lds
    v_mfma_f32_16x16x32_bf16 v[156:159], a[36:39], v[108:111], v[156:159]
    s_waitcnt lgkmcnt(2)
    s_add_u32 m0, s60, 94208
    v_mul_f32 v62, s34, v62
    v_mfma_f32_16x16x32_bf16 v[156:159], a[44:47], v[112:115], v[156:159]
    s_xor_b32 s54, s59, 1150976
    v_mul_f32 v60, v61, v60
    v_mul_f32 v63, s34, v63
    v_mfma_f32_16x16x32_bf16 v[152:155], a[40:43], v[112:115], v[152:155]
    v_mul_f32 v41, s34, v60
    v_fma_f32 v49, -v62, v60, v63
    v_mfma_f32_16x16x32_bf16 v[152:155], a[32:35], v[108:111], v[152:155]
    ds_read_b128 v[124:127], v2 offset:7168
    v_lshlrev_b32 v56, 16, v21
    v_mfma_f32_16x16x32_bf16 v[152:155], a[24:27], v[104:107], v[152:155]
    v_lshlrev_b32 v57, 16, v25
    v_lshlrev_b32 v58, 16, v17
    v_mfma_f32_16x16x32_bf16 v[160:163], a[24:27], v[108:111], v[160:163]
    buffer_load_dwordx4 v7, s[12:15], s54 offen lds
    v_mfma_f32_16x16x32_bf16 v[160:163], a[32:35], v[112:115], v[160:163]
    s_waitcnt lgkmcnt(2)
    s_add_u32 m0, s61, 49152
    v_lshlrev_b32 v59, 16, v29
    v_mfma_f32_16x16x32_bf16 v[160:163], a[40:43], v[116:119], v[160:163]
    s_xor_b32 s55, s58, 8320
    v_add_f32 v56, 0x3727c5ac, v56
    v_mfma_f32_16x16x32_bf16 v[164:167], a[44:47], v[116:119], v[164:167]
    v_sqrt_f32 v56, v56
    v_mfma_f32_16x16x32_bf16 v[164:167], a[36:39], v[112:115], v[164:167]
    ds_read_b128 v[96:99], v2 offset:16384
    v_mfma_f32_16x16x32_bf16 v[164:167], a[28:31], v[108:111], v[164:167]
    v_rcp_f32 v56, v56
    v_mfma_f32_16x16x32_bf16 v[172:175], a[28:31], v[112:115], v[172:175]
    buffer_load_dwordx4 v8, s[8:11], s55 offen offset:0 nt lds
    v_mfma_f32_16x16x32_bf16 v[172:175], a[36:39], v[116:119], v[172:175]
    s_waitcnt lgkmcnt(2)
    v_mul_f32 v58, s34, v58
    v_mul_f32 v56, v57, v56
    v_mfma_f32_16x16x32_bf16 v[172:175], a[44:47], v[120:123], v[172:175]
    v_mul_f32 v59, s34, v59
    v_mul_f32 v42, s34, v56
    v_mfma_f32_16x16x32_bf16 v[168:171], a[40:43], v[120:123], v[168:171]
    v_fma_f32 v50, -v58, v56, v59
    v_and_b32 v60, 0xffff0000, v21
    v_mfma_f32_16x16x32_bf16 v[168:171], a[32:35], v[116:119], v[168:171]
    s_waitcnt vmcnt(7) lgkmcnt(1)
    ds_read_b128 v[100:103], v2 offset:17408
    v_and_b32 v61, 0xffff0000, v25
    v_mfma_f32_16x16x32_bf16 v[168:171], a[24:27], v[112:115], v[168:171]
    s_barrier
    ds_read_b64_tr_b16 a[8:9], v5 offset:8192
    v_and_b32 v62, 0xffff0000, v17
L_stub0:
    s_cbranch_vccnz L_back0
    v_mfma_f32_16x16x32_bf16 v[176:179], a[24:27], v[116:119], v[176:179]
    buffer_load_dwordx4 v8, s[8:11], s55 offen offset:2048 nt lds
    v_mfma_f32_16x16x32_bf16 v[176:179], a[32:35], v[120:123], v[176:179]
    s_add_u32 m0, s61, 53248
    ds_read_b64_tr_b16 a[10:11], v5 offset:12288
    v_and_b32 v63, 0xffff0000, v29
    v_mfma_f32_16x16x32_bf16 v[176:179], a[40:43], v[124:127], v[176:179]
    s_xor_b32 s52, s58, 12416
    ds_read_b64_tr_b16 a[16:17], v5 offset:16384
    v_add_f32 v60, 0x3727c5ac, v60
    v_mfma_f32_16x16x32_bf16 v[180:183], a[44:47], v[124:127], v[180:183]
    ds_read_b64_tr_b16 a[18:19], v5 offset:20480
    v_mfma_f32_16x16x32_bf16 v[180:183], a[36:39], v[120:123], v[180:183]
    ds_read_b128 v[104:107], v2 offset:18432
    v_mfma_f32_16x16x32_bf16 v[180:183], a[28:31], v[116:119], v[180:183]
    buffer_load_dwordx4 v8, s[8:11], s52 offen offset:0 nt lds
    v_mfma_f32_16x16x32_bf16 v[188:191], a[28:31], v[120:123], v[188:191]
    ds_read_b64_tr_b16 a[20:21], v6 offset:16384
    v_mfma_f32_16x16x32_bf16 v[188:191], a[36:39], v[124:127], v[188:191]
    s_waitcnt lgkmcnt(7)
    ds_read_b64_tr_b16 a[22:23], v6 offset:20480
    v_mfma_f32_16x16x32_bf16 v[188:191], a[44:47], v[96:99], v[188:191]
    ds_read_b64_tr_b16 a[12:13], v6 offset:8192
    v_mfma_f32_16x16x32_bf16 v[184:187], a[40:43], v[96:99], v[184:187]
    ds_read_b64_tr_b16 a[14:15], v6 offset:12288
    v_mfma_f32_16x16x32_bf16 v[184:187], a[32:35], v[124:127], v[184:187]
    ds_read_b128 v[108:111], v2 offset:19456
    v_mfma_f32_16x16x32_bf16 v[184:187], a[24:27], v[120:123], v[184:187]
    buffer_load_dwordx4 v8, s[8:11], s52 offen offset:2048 nt lds
    v_mfma_f32_16x16x32_bf16 v[192:195], a[24:27], v[124:127], v[192:195]
    s_add_u32 m0, s60, 0
    ds_read_b64_tr_b16 a[4:5], v6 offset:0
    v_mfma_f32_16x16x32_bf16 v[192:195], a[32:35], v[96:99], v[192:195]
    s_waitcnt lgkmcnt(11)
    ds_read_b64_tr_b16 a[6:7], v6 offset:4096
    v_mfma_f32_16x16x32_bf16 v[192:195], a[40:43], v[100:103], v[192:195]
    s_xor_b32 s53, s59, 327680
    ds_read_b64_tr_b16 a[0:1], v5 offset:0
    v_mfma_f32_16x16x32_bf16 v[196:199], a[44:47], v[100:103], v[196:199]
    ds_read_b64_tr_b16 a[2:3], v5 offset:4096
    v_mfma_f32_16x16x32_bf16 v[196:199], a[36:39], v[96:99], v[196:199]
    ds_read_b128 v[112:115], v2 offset:20480
    v_mfma_f32_16x16x32_bf16 v[196:199], a[28:31], v[124:127], v[196:199]
    buffer_load_dwordx4 v7, s[12:15], s53 offen lds
    v_mfma_f32_16x16x32_bf16 v[204:207], a[28:31], v[96:99], v[204:207]
    s_add_u32 m0, s60, 4096
    v_sqrt_f32 v60, v60
    v_mfma_f32_16x16x32_bf16 v[204:207], a[36:39], v[100:103], v[204:207]
    s_waitcnt lgkmcnt(10)
    v_rcp_f32 v60, v60
    v_mfma_f32_16x16x32_bf16 v[204:207], a[44:47], v[104:107], v[204:207]
    s_xor_b32 s54, s59, 331776
    v_mul_f32 v62, s34, v62
    v_mul_f32 v60, v61, v60
    v_mfma_f32_16x16x32_bf16 v[200:203], a[40:43], v[104:107], v[200:203]
    v_mul_f32 v63, s34, v63
    v_mul_f32 v43, s34, v60
    v_mfma_f32_16x16x32_bf16 v[200:203], a[32:35], v[100:103], v[200:203]
    ds_read_b128 v[116:119], v2 offset:21504
    v_fma_f32 v51, -v62, v60, v63
    v_mfma_f32_16x16x32_bf16 v[200:203], a[24:27], v[96:99], v[200:203]
    buffer_load_dwordx4 v7, s[12:15], s54 offen lds
    v_mfma_f32_16x16x32_bf16 v[208:211], a[24:27], v[100:103], v[208:211]
    s_add_u32 m0, s60, 8192
    s_xor_b32 s55, s59, 851968
    v_lshlrev_b32 v56, 16, v22
    v_mfma_f32_16x16x32_bf16 v[208:211], a[32:35], v[104:107], v[208:211]
    s_waitcnt lgkmcnt(6)
    v_lshlrev_b32 v57, 16, v26
    v_lshlrev_b32 v58, 16, v18
    v_mfma_f32_16x16x32_bf16 v[208:211], a[40:43], v[108:111], v[208:211]
    v_lshlrev_b32 v59, 16, v30
    v_add_f32 v56, 0x3727c5ac, v56
    v_mfma_f32_16x16x32_bf16 v[212:215], a[44:47], v[108:111], v[212:215]
    v_sqrt_f32 v56, v56
    v_mfma_f32_16x16x32_bf16 v[212:215], a[36:39], v[104:107], v[212:215]
    ds_read_b128 v[120:123], v2 offset:22528
    v_mfma_f32_16x16x32_bf16 v[212:215], a[28:31], v[100:103], v[212:215]
    buffer_load_dwordx4 v7, s[12:15], s55 offen lds
    v_mfma_f32_16x16x32_bf16 v[220:223], a[28:31], v[104:107], v[220:223]
    s_add_u32 m0, s60, 12288
    v_rcp_f32 v56, v56
    v_mfma_f32_16x16x32_bf16 v[220:223], a[36:39], v[108:111], v[220:223]
    s_waitcnt lgkmcnt(2)
    s_xor_b32 s52, s59, 856064
    v_mul_f32 v58, s34, v58
    v_mfma_f32_16x16x32_bf16 v[220:223], a[44:47], v[112:115], v[220:223]
    v_mul_f32 v56, v57, v56
    v_mul_f32 v59, s34, v59
    v_mfma_f32_16x16x32_bf16 v[216:219], a[40:43], v[112:115], v[216:219]
    v_mul_f32 v44, s34, v56
    v_fma_f32 v52, -v58, v56, v59
    v_mfma_f32_16x16x32_bf16 v[216:219], a[32:35], v[108:111], v[216:219]
    buffer_load_dwordx4 v7, s[12:15], s52 offen lds
    v_mfma_f32_16x16x32_bf16 v[216:219], a[24:27], v[104:107], v[216:219]
    s_add_u32 m0, s60, 16384
    ds_read_b128 v[124:127], v2 offset:23552
    v_and_b32 v60, 0xffff0000, v22
    v_mfma_f32_16x16x32_bf16 v[224:227], a[24:27], v[108:111], v[224:227]
    s_xor_b32 s53, s59, 1376256
    v_and_b32 v61, 0xffff0000, v26
    v_and_b32 v62, 0xffff0000, v18
    v_mfma_f32_16x16x32_bf16 v[224:227], a[32:35], v[112:115], v[224:227]
    s_waitcnt lgkmcnt(2)
    v_and_b32 v63, 0xffff0000, v30
    v_add_f32 v60, 0x3727c5ac, v60
    v_mfma_f32_16x16x32_bf16 v[224:227], a[40:43], v[116:119], v[224:227]
    v_sqrt_f32 v60, v60
    v_mfma_f32_16x16x32_bf16 v[228:231], a[44:47], v[116:119], v[228:231]
    v_rcp_f32 v60, v60
    v_mfma_f32_16x16x32_bf16 v[228:231], a[36:39], v[112:115], v[228:231]
    buffer_load_dwordx4 v7, s[12:15], s53 offen lds
    v_mfma_f32_16x16x32_bf16 v[228:231], a[28:31], v[108:111], v[228:231]
    s_add_u32 m0, s60, 20480
    s_xor_b32 s54, s59, 1380352
    v_mul_f32 v62, s34, v62
    v_mfma_f32_16x16x32_bf16 v[236:239], a[28:31], v[112:115], v[236:239]
    ds_read_b128 v[96:99], v1 offset:32768
    v_mul_f32 v60, v61, v60
    v_mfma_f32_16x16x32_bf16 v[236:239], a[36:39], v[116:119], v[236:239]
    s_waitcnt lgkmcnt(2)
    ds_read_b128 v[100:103], v1 offset:33792
    v_mul_f32 v63, s34, v63
    v_mfma_f32_16x16x32_bf16 v[236:239], a[44:47], v[120:123], v[236:239]
    v_mul_f32 v45, s34, v60
    v_fma_f32 v53, -v62, v60, v63
    v_mfma_f32_16x16x32_bf16 v[232:235], a[40:43], v[120:123], v[232:235]
    v_lshlrev_b32 v56, 16, v23
    v_lshlrev_b32 v57, 16, v27
    v_mfma_f32_16x16x32_bf16 v[232:235], a[32:35], v[116:119], v[232:235]
    buffer_load_dwordx4 v7, s[12:15], s54 offen lds
    v_mfma_f32_16x16x32_bf16 v[232:235], a[24:27], v[112:115], v[232:235]
    s_add_u32 m0, s60, 24576
    s_xor_b32 s55, s59, 131072
    v_lshlrev_b32 v58, 16, v19
    v_mfma_f32_16x16x32_bf16 v[240:243], a[24:27], v[116:119], v[240:243]
    ds_read_b128 v[104:107], v1 offset:34816
    v_lshlrev_b32 v59, 16, v31
    v_mfma_f32_16x16x32_bf16 v[240:243], a[32:35], v[120:123], v[240:243]
    s_waitcnt lgkmcnt(3)
    v_add_f32 v56, 0x3727c5ac, v56
    v_mfma_f32_16x16x32_bf16 v[240:243], a[40:43], v[124:127], v[240:243]
    v_sqrt_f32 v56, v56
    v_mfma_f32_16x16x32_bf16 v[244:247], a[44:47], v[124:127], v[244:247]
    v_rcp_f32 v56, v56
    v_mfma_f32_16x16x32_bf16 v[244:247], a[36:39], v[120:123], v[244:247]
    buffer_load_dwordx4 v7, s[12:15], s55 offen lds
    v_mfma_f32_16x16x32_bf16 v[244:247], a[28:31], v[116:119], v[244:247]
    s_add_u32 m0, s60, 28672
    s_xor_b32 s52, s59, 135168
    v_mul_f32 v58, s34, v58
    v_mfma_f32_16x16x32_bf16 v[252:255], a[28:31], v[120:123], v[252:255]
    ds_read_b128 v[108:111], v1 offset:35840
    v_mul_f32 v56, v57, v56
    v_mfma_f32_16x16x32_bf16 v[252:255], a[36:39], v[124:127], v[252:255]
    v_mul_f32 v59, s34, v59
    v_mul_f32 v46, s34, v56
    v_mfma_f32_16x16x32_bf16 v[248:251], a[32:35], v[124:127], v[248:251]
    v_fma_f32 v54, -v58, v56, v59
    v_and_b32 v60, 0xffff0000, v23
    v_mfma_f32_16x16x32_bf16 v[248:251], a[24:27], v[120:123], v[248:251]
    s_waitcnt lgkmcnt(3)
    v_and_b32 v61, 0xffff0000, v27
    v_and_b32 v62, 0xffff0000, v19
    v_mfma_f32_16x16x32_bf16 v[128:131], a[8:11], v[96:99], v[128:131]
    s_waitcnt lgkmcnt(2)
    v_and_b32 v63, 0xffff0000, v31
    v_add_f32 v60, 0x3727c5ac, v60
    v_mfma_f32_16x16x32_bf16 v[128:131], a[16:19], v[100:103], v[128:131]
    buffer_load_dwordx4 v7, s[12:15], s52 offen lds
    v_mfma_f32_16x16x32_bf16 v[132:135], a[20:23], v[100:103], v[132:135]
    s_add_u32 m0, s60, 32768
    ds_read_b128 v[112:115], v1 offset:36864
    v_mfma_f32_16x16x32_bf16 v[132:135], a[12:15], v[96:99], v[132:135]
    s_xor_b32 s53, s59, 655360
    v_sqrt_f32 v60, v60
    v_mfma_f32_16x16x32_bf16 v[140:143], a[4:7], v[96:99], v[140:143]
    v_rcp_f32 v60, v60
    v_mfma_f32_16x16x32_bf16 v[140:143], a[12:15], v[100:103], v[140:143]
    s_waitcnt lgkmcnt(2)
    v_mul_f32 v62, s34, v62
    v_mul_f32 v60, v61, v60
    v_mfma_f32_16x16x32_bf16 v[140:143], a[20:23], v[104:107], v[140:143]
    v_mul_f32 v63, s34, v63
    v_mul_f32 v47, s34, v60
    v_mfma_f32_16x16x32_bf16 v[136:139], a[16:19], v[104:107], v[136:139]
    buffer_load_dwordx4 v7, s[12:15], s53 offen lds
    v_mfma_f32_16x16x32_bf16 v[136:139], a[8:11], v[100:103], v[136:139]
    s_add_u32 m0, s60, 36864
    ds_read_b128 v[116:119], v1 offset:37888
    v_fma_f32 v55, -v62, v60, v63
    v_mfma_f32_16x16x32_bf16 v[136:139], a[0:3], v[96:99], v[136:139]
    s_xor_b32 s54, s59, 659456
    v_mfma_f32_16x16x32_bf16 v[144:147], a[0:3], v[100:103], v[144:147]
    v_mfma_f32_16x16x32_bf16 v[144:147], a[8:11], v[104:107], v[144:147]
    s_waitcnt lgkmcnt(2)
    v_mfma_f32_16x16x32_bf16 v[144:147], a[16:19], v[108:111], v[144:147]
    v_mfma_f32_16x16x32_bf16 v[148:151], a[20:23], v[108:111], v[148:151]
    buffer_load_dwordx4 v7, s[12:15], s54 offen lds
    v_mfma_f32_16x16x32_bf16 v[148:151], a[12:15], v[104:107], v[148:151]
    s_add_u32 m0, s60, 40960
    s_xor_b32 s55, s59, 1179648
    ds_read_b128 v[120:123], v1 offset:38912
    v_mfma_f32_16x16x32_bf16 v[148:151], a[4:7], v[100:103], v[148:151]
    v_mfma_f32_16x16x32_bf16 v[156:159], a[4:7], v[104:107], v[156:159]
    v_mfma_f32_16x16x32_bf16 v[156:159], a[12:15], v[108:111], v[156:159]
    s_waitcnt lgkmcnt(2)
    v_mfma_f32_16x16x32_bf16 v[156:159], a[20:23], v[112:115], v[156:159]
    v_mfma_f32_16x16x32_bf16 v[152:155], a[16:19], v[112:115], v[152:155]
    buffer_load_dwordx4 v7, s[12:15], s55 offen lds
    v_mfma_f32_16x16x32_bf16 v[152:155], a[8:11], v[108:111], v[152:155]
    s_add_u32 m0, s60, 45056
    s_xor_b32 s52, s59, 1183744
    ds_read_b128 v[124:127], v1 offset:39936
    v_mfma_f32_16x16x32_bf16 v[152:155], a[0:3], v[104:107], v[152:155]
    v_mfma_f32_16x16x32_bf16 v[160:163], a[0:3], v[108:111], v[160:163]
    v_mfma_f32_16x16x32_bf16 v[160:163], a[8:11], v[112:115], v[160:163]
    s_waitcnt lgkmcnt(2)
    v_mfma_f32_16x16x32_bf16 v[160:163], a[16:19], v[116:119], v[160:163]
    v_mfma_f32_16x16x32_bf16 v[164:167], a[20:23], v[116:119], v[164:167]
    buffer_load_dwordx4 v7, s[12:15], s52 offen lds
    v_mfma_f32_16x16x32_bf16 v[164:167], a[12:15], v[112:115], v[164:167]
    s_add_u32 m0, s61, 0
    s_xor_b32 s53, s58, 256
    v_mfma_f32_16x16x32_bf16 v[164:167], a[4:7], v[108:111], v[164:167]
    v_mfma_f32_16x16x32_bf16 v[172:175], a[4:7], v[112:115], v[172:175]
    v_mfma_f32_16x16x32_bf16 v[172:175], a[12:15], v[116:119], v[172:175]
    s_waitcnt lgkmcnt(1)
    v_mfma_f32_16x16x32_bf16 v[172:175], a[20:23], v[120:123], v[172:175]
    v_mfma_f32_16x16x32_bf16 v[168:171], a[16:19], v[120:123], v[168:171]
    buffer_load_dwordx4 v8, s[8:11], s53 offen offset:0 nt lds
    v_mfma_f32_16x16x32_bf16 v[168:171], a[8:11], v[116:119], v[168:171]
    s_waitcnt vmcnt(13)
    v_mfma_f32_16x16x32_bf16 v[168:171], a[0:3], v[112:115], v[168:171]
    s_barrier
    ds_read_b128 v[96:99], v1 offset:49152
    v_mfma_f32_16x16x32_bf16 v[176:179], a[0:3], v[116:119], v[176:179]
    ds_read_b128 v[100:103], v1 offset:50176
    v_mfma_f32_16x16x32_bf16 v[176:179], a[8:11], v[120:123], v[176:179]
    s_waitcnt lgkmcnt(2)
    ds_read_b64_tr_b16 a[32:33], v5 offset:32768
    v_mfma_f32_16x16x32_bf16 v[176:179], a[16:19], v[124:127], v[176:179]
    buffer_load_dwordx4 v8, s[8:11], s53 offen offset:2048 nt lds
    v_mfma_f32_16x16x32_bf16 v[180:183], a[20:23], v[124:127], v[180:183]
    s_add_u32 m0, s61, 4096
    s_xor_b32 s54, s58, 4352
    ds_read_b64_tr_b16 a[34:35], v5 offset:36864
    v_mfma_f32_16x16x32_bf16 v[180:183], a[12:15], v[120:123], v[180:183]
    ds_read_b128 v[104:107], v1 offset:51200
    v_mfma_f32_16x16x32_bf16 v[180:183], a[4:7], v[116:119], v[180:183]
    ds_read_b64_tr_b16 a[36:37], v6 offset:32768
    v_mfma_f32_16x16x32_bf16 v[188:191], a[4:7], v[120:123], v[188:191]
    ds_read_b64_tr_b16 a[38:39], v6 offset:36864
    v_mfma_f32_16x16x32_bf16 v[188:191], a[12:15], v[124:127], v[188:191]
    s_waitcnt lgkmcnt(6)
    ds_read_b64_tr_b16 a[40:41], v5 offset:40960
    v_mfma_f32_16x16x32_bf16 v[188:191], a[20:23], v[96:99], v[188:191]
    buffer_load_dwordx4 v8, s[8:11], s54 offen offset:0 nt lds
    v_mfma_f32_16x16x32_bf16 v[184:187], a[16:19], v[96:99], v[184:187]
    ds_read_b64_tr_b16 a[42:43], v5 offset:45056
    v_mfma_f32_16x16x32_bf16 v[184:187], a[8:11], v[124:127], v[184:187]
    ds_read_b128 v[108:111], v1 offset:52224
    v_mfma_f32_16x16x32_bf16 v[184:187], a[0:3], v[120:123], v[184:187]
    ds_read_b64_tr_b16 a[44:45], v6 offset:40960
    v_mfma_f32_16x16x32_bf16 v[192:195], a[0:3], v[124:127], v[192:195]
    ds_read_b64_tr_b16 a[46:47], v6 offset:45056
    v_mfma_f32_16x16x32_bf16 v[192:195], a[8:11], v[96:99], v[192:195]
    s_waitcnt lgkmcnt(10)
    ds_read_b64_tr_b16 a[24:25], v5 offset:24576
    v_mfma_f32_16x16x32_bf16 v[192:195], a[16:19], v[100:103], v[192:195]
    buffer_load_dwordx4 v8, s[8:11], s54 offen offset:2048 nt lds
    v_mfma_f32_16x16x32_bf16 v[196:199], a[20:23], v[100:103], v[196:199]
    s_add_u32 m0, s60, 49152
    s_xor_b32 s55, s59, 360448
    ds_read_b64_tr_b16 a[26:27], v5 offset:28672
    v_mfma_f32_16x16x32_bf16 v[196:199], a[12:15], v[96:99], v[196:199]
    ds_read_b128 v[112:115], v1 offset:53248
    v_mfma_f32_16x16x32_bf16 v[196:199], a[4:7], v[124:127], v[196:199]
    ds_read_b64_tr_b16 a[28:29], v6 offset:24576
    v_mfma_f32_16x16x32_bf16 v[204:207], a[4:7], v[96:99], v[204:207]
    ds_read_b64_tr_b16 a[30:31], v6 offset:28672
    v_mfma_f32_16x16x32_bf16 v[204:207], a[12:15], v[100:103], v[204:207]
    s_waitcnt lgkmcnt(12)
    v_mfma_f32_16x16x32_bf16 v[204:207], a[20:23], v[104:107], v[204:207]
    buffer_load_dwordx4 v7, s[12:15], s55 offen lds
    v_mfma_f32_16x16x32_bf16 v[200:203], a[16:19], v[104:107], v[200:203]
    s_add_u32 m0, s60, 53248
    s_xor_b32 s52, s59, 364544
    v_mfma_f32_16x16x32_bf16 v[200:203], a[8:11], v[100:103], v[200:203]
    ds_read_b128 v[116:119], v1 offset:54272
    v_mfma_f32_16x16x32_bf16 v[200:203], a[0:3], v[96:99], v[200:203]
    v_mfma_f32_16x16x32_bf16 v[208:211], a[0:3], v[100:103], v[208:211]
    v_mfma_f32_16x16x32_bf16 v[208:211], a[8:11], v[104:107], v[208:211]
    s_waitcnt lgkmcnt(8)
    v_mfma_f32_16x16x32_bf16 v[208:211], a[16:19], v[108:111], v[208:211]
    buffer_load_dwordx4 v7, s[12:15], s52 offen lds
    v_mfma_f32_16x16x32_bf16 v[212:215], a[20:23], v[108:111], v[212:215]
    s_add_u32 m0, s60, 57344
    s_xor_b32 s53, s59, 884736
    v_mfma_f32_16x16x32_bf16 v[212:215], a[12:15], v[104:107], v[212:215]
    ds_read_b128 v[120:123], v1 offset:55296
    v_mfma_f32_16x16x32_bf16 v[212:215], a[4:7], v[100:103], v[212:215]
    v_mfma_f32_16x16x32_bf16 v[220:223], a[4:7], v[104:107], v[220:223]
    v_mfma_f32_16x16x32_bf16 v[220:223], a[12:15], v[108:111], v[220:223]
    s_waitcnt lgkmcnt(4)
    v_mfma_f32_16x16x32_bf16 v[220:223], a[20:23], v[112:115], v[220:223]
    buffer_load_dwordx4 v7, s[12:15], s53 offen lds
    v_mfma_f32_16x16x32_bf16 v[216:219], a[16:19], v[112:115], v[216:219]
    s_add_u32 m0, s60, 61440
    s_xor_b32 s54, s59, 888832
    v_mfma_f32_16x16x32_bf16 v[216:219], a[8:11], v[108:111], v[216:219]
    s_waitcnt vmcnt(13) lgkmcnt(2)
    ds_read_b128 v[124:127], v1 offset:56320
    v_mfma_f32_16x16x32_bf16 v[216:219], a[0:3], v[104:107], v[216:219]
    s_barrier
    ds_read_b64_tr_b16 a[56:57], v3 offset:8192
    v_mfma_f32_16x16x32_bf16 v[224:227], a[0:3], v[108:111], v[224:227]
    ds_read_b64_tr_b16 a[58:59], v3 offset:12288
    v_mfma_f32_16x16x32_bf16 v[224:227], a[8:11], v[112:115], v[224:227]
    s_waitcnt lgkmcnt(4)
    ds_read_b64_tr_b16 a[60:61], v4 offset:8192
    v_mfma_f32_16x16x32_bf16 v[224:227], a[16:19], v[116:119], v[224:227]
    buffer_load_dwordx4 v7, s[12:15], s54 offen lds
    v_mfma_f32_16x16x32_bf16 v[228:231], a[20:23], v[116:119], v[228:231]
    s_add_u32 m0, s60, 65536
    s_xor_b32 s55, s59, 1409024
    ds_read_b64_tr_b16 a[62:63], v4 offset:12288
    v_mfma_f32_16x16x32_bf16 v[228:231], a[12:15], v[112:115], v[228:231]
    ds_read_b64_tr_b16 a[64:65], v3 offset:16384
    v_mfma_f32_16x16x32_bf16 v[228:231], a[4:7], v[108:111], v[228:231]
    ds_read_b64_tr_b16 a[66:67], v3 offset:20480
    v_mfma_f32_16x16x32_bf16 v[236:239], a[4:7], v[112:115], v[236:239]
    ds_read_b128 v[96:99], v2 offset:32768
    v_mfma_f32_16x16x32_bf16 v[236:239], a[12:15], v[116:119], v[236:239]
    s_waitcnt lgkmcnt(8)
    ds_read_b128 v[100:103], v2 offset:33792
    v_mfma_f32_16x16x32_bf16 v[236:239], a[20:23], v[120:123], v[236:239]
    buffer_load_dwordx4 v7, s[12:15], s55 offen lds
    v_mfma_f32_16x16x32_bf16 v[232:235], a[16:19], v[120:123], v[232:235]
    s_add_u32 m0, s60, 69632
    s_xor_b32 s52, s59, 1413120
    ds_read_b64_tr_b16 a[68:69], v4 offset:16384
    v_mfma_f32_16x16x32_bf16 v[232:235], a[8:11], v[116:119], v[232:235]
    ds_read_b64_tr_b16 a[70:71], v4 offset:20480
    v_mfma_f32_16x16x32_bf16 v[232:235], a[0:3], v[112:115], v[232:235]
    ds_read_b64_tr_b16 a[48:49], v3 offset:0
    v_mfma_f32_16x16x32_bf16 v[240:243], a[0:3], v[116:119], v[240:243]
    ds_read_b128 v[104:107], v2 offset:34816
    v_mfma_f32_16x16x32_bf16 v[240:243], a[8:11], v[120:123], v[240:243]
    s_waitcnt lgkmcnt(12)
    ds_read_b64_tr_b16 a[50:51], v3 offset:4096
    v_mfma_f32_16x16x32_bf16 v[240:243], a[16:19], v[124:127], v[240:243]
    buffer_load_dwordx4 v7, s[12:15], s52 offen lds
    v_mfma_f32_16x16x32_bf16 v[244:247], a[20:23], v[124:127], v[244:247]
    s_add_u32 m0, s61, 16384
    s_xor_b32 s53, s58, 8448
    ds_read_b64_tr_b16 a[52:53], v4 offset:0
    v_mfma_f32_16x16x32_bf16 v[244:247], a[12:15], v[120:123], v[244:247]
    ds_read_b64_tr_b16 a[54:55], v4 offset:4096
    v_mfma_f32_16x16x32_bf16 v[244:247], a[4:7], v[116:119], v[244:247]
    v_mfma_f32_16x16x32_bf16 v[252:255], a[4:7], v[120:123], v[252:255]
    v_mfma_f32_16x16x32_bf16 v[252:255], a[12:15], v[124:127], v[252:255]
    v_mfma_f32_16x16x32_bf16 v[248:251], a[8:11], v[124:127], v[248:251]
    buffer_load_dwordx4 v8, s[8:11], s53 offen offset:0 nt lds
    v_mfma_f32_16x16x32_bf16 v[248:251], a[0:3], v[120:123], v[248:251]
    s_waitcnt lgkmcnt(8)
    ds_read_b128 v[108:111], v2 offset:35840
    v_mfma_f32_16x16x32_bf16 v[128:131], a[32:35], v[96:99], v[128:131]
    s_waitcnt lgkmcnt(8)
    v_mfma_f32_16x16x32_bf16 v[128:131], a[40:43], v[100:103], v[128:131]
    v_mfma_f32_16x16x32_bf16 v[132:135], a[44:47], v[100:103], v[132:135]
    ds_read_b128 v[112:115], v2 offset:36864
    v_mfma_f32_16x16x32_bf16 v[132:135], a[36:39], v[96:99], v[132:135]
    v_mfma_f32_16x16x32_bf16 v[140:143], a[28:31], v[96:99], v[140:143]
    buffer_load_dwordx4 v8, s[8:11], s53 offen offset:2048 nt lds
    v_mfma_f32_16x16x32_bf16 v[140:143], a[36:39], v[100:103], v[140:143]
    s_waitcnt lgkmcnt(5)
    s_add_u32 m0, s61, 20480
    s_xor_b32 s54, s58, 12544
    v_mfma_f32_16x16x32_bf16 v[140:143], a[44:47], v[104:107], v[140:143]
    v_mfma_f32_16x16x32_bf16 v[136:139], a[40:43], v[104:107], v[136:139]
    v_mfma_f32_16x16x32_bf16 v[136:139], a[32:35], v[100:103], v[136:139]
    ds_read_b128 v[116:119], v2 offset:37888
    v_mfma_f32_16x16x32_bf16 v[136:139], a[24:27], v[96:99], v[136:139]
    v_mfma_f32_16x16x32_bf16 v[144:147], a[24:27], v[100:103], v[144:147]
    buffer_load_dwordx4 v8, s[8:11], s54 offen offset:0 nt lds
    v_mfma_f32_16x16x32_bf16 v[144:147], a[32:35], v[104:107], v[144:147]
    s_waitcnt lgkmcnt(2)
    v_mfma_f32_16x16x32_bf16 v[144:147], a[40:43], v[108:111], v[144:147]
    v_mfma_f32_16x16x32_bf16 v[148:151], a[44:47], v[108:111], v[148:151]
    v_mfma_f32_16x16x32_bf16 v[148:151], a[36:39], v[104:107], v[148:151]
    ds_read_b128 v[120:123], v2 offset:38912
    v_mfma_f32_16x16x32_bf16 v[148:151], a[28:31], v[100:103], v[148:151]
    v_mfma_f32_16x16x32_bf16 v[156:159], a[28:31], v[104:107], v[156:159]
    buffer_load_dwordx4 v8, s[8:11], s54 offen offset:2048 nt lds
    v_mfma_f32_16x16x32_bf16 v[156:159], a[36:39], v[108:111], v[156:159]
    s_waitcnt lgkmcnt(2)
    s_add_u32 m0, s60, 73728
    s_xor_b32 s55, s59, 163840
    v_mfma_f32_16x16x32_bf16 v[156:159], a[44:47], v[112:115], v[156:159]
    v_mfma_f32_16x16x32_bf16 v[152:155], a[40:43], v[112:115], v[152:155]
    v_mfma_f32_16x16x32_bf16 v[152:155], a[32:35], v[108:111], v[152:155]
    ds_read_b128 v[124:127], v2 offset:39936
    v_mfma_f32_16x16x32_bf16 v[152:155], a[24:27], v[104:107], v[152:155]
    buffer_load_dwordx4 v7, s[12:15], s55 offen lds
    v_mfma_f32_16x16x32_bf16 v[160:163], a[24:27], v[108:111], v[160:163]
    s_add_u32 m0, s60, 77824
    s_xor_b32 s52, s59, 167936
    v_mfma_f32_16x16x32_bf16 v[160:163], a[32:35], v[112:115], v[160:163]
    s_waitcnt lgkmcnt(2)
    v_mfma_f32_16x16x32_bf16 v[160:163], a[40:43], v[116:119], v[160:163]
    v_mfma_f32_16x16x32_bf16 v[164:167], a[44:47], v[116:119], v[164:167]
    v_mfma_f32_16x16x32_bf16 v[164:167], a[36:39], v[112:115], v[164:167]
    ds_read_b128 v[96:99], v2 offset:49152
    v_mfma_f32_16x16x32_bf16 v[164:167], a[28:31], v[108:111], v[164:167]
    buffer_load_dwordx4 v7, s[12:15], s52 offen lds
    v_mfma_f32_16x16x32_bf16 v[172:175], a[28:31], v[112:115], v[172:175]
    s_add_u32 m0, s60, 81920
    s_xor_b32 s53, s59, 688128
    v_mfma_f32_16x16x32_bf16 v[172:175], a[36:39], v[116:119], v[172:175]
    s_waitcnt lgkmcnt(2)
    v_mfma_f32_16x16x32_bf16 v[172:175], a[44:47], v[120:123], v[172:175]
    v_mfma_f32_16x16x32_bf16 v[168:171], a[40:43], v[120:123], v[168:171]
    v_mfma_f32_16x16x32_bf16 v[168:171], a[32:35], v[116:119], v[168:171]
    s_waitcnt vmcnt(12) lgkmcnt(1)
    ds_read_b128 v[100:103], v2 offset:50176
    v_mfma_f32_16x16x32_bf16 v[168:171], a[24:27], v[112:115], v[168:171]
    s_barrier
    ds_read_b64_tr_b16 a[8:9], v3 offset:32768
    v_mfma_f32_16x16x32_bf16 v[176:179], a[24:27], v[116:119], v[176:179]
    buffer_load_dwordx4 v7, s[12:15], s53 offen lds
    v_mfma_f32_16x16x32_bf16 v[176:179], a[32:35], v[120:123], v[176:179]
    s_add_u32 m0, s60, 86016
    s_xor_b32 s54, s59, 692224
    ds_read_b64_tr_b16 a[10:11], v3 offset:36864
    v_mfma_f32_16x16x32_bf16 v[176:179], a[40:43], v[124:127], v[176:179]
    ds_read_b64_tr_b16 a[12:13], v4 offset:32768
    v_mfma_f32_16x16x32_bf16 v[180:183], a[44:47], v[124:127], v[180:183]
    ds_read_b64_tr_b16 a[14:15], v4 offset:36864
    v_mfma_f32_16x16x32_bf16 v[180:183], a[36:39], v[120:123], v[180:183]
    ds_read_b128 v[104:107], v2 offset:51200
    v_mfma_f32_16x16x32_bf16 v[180:183], a[28:31], v[116:119], v[180:183]
    ds_read_b64_tr_b16 a[16:17], v3 offset:40960
    v_mfma_f32_16x16x32_bf16 v[188:191], a[28:31], v[120:123], v[188:191]
    buffer_load_dwordx4 v7, s[12:15], s54 offen lds
    v_mfma_f32_16x16x32_bf16 v[188:191], a[36:39], v[124:127], v[188:191]
    s_waitcnt lgkmcnt(7)
    s_add_u32 m0, s60, 90112
    ds_read_b64_tr_b16 a[18:19], v3 offset:45056
    v_mfma_f32_16x16x32_bf16 v[188:191], a[44:47], v[96:99], v[188:191]
    s_xor_b32 s55, s59, 1212416
    ds_read_b64_tr_b16 a[20:21], v4 offset:40960
    v_mfma_f32_16x16x32_bf16 v[184:187], a[40:43], v[96:99], v[184:187]
    ds_read_b64_tr_b16 a[22:23], v4 offset:45056
    v_mfma_f32_16x16x32_bf16 v[184:187], a[32:35], v[124:127], v[184:187]
    ds_read_b128 v[108:111], v2 offset:52224
    v_mfma_f32_16x16x32_bf16 v[184:187], a[24:27], v[120:123], v[184:187]
    ds_read_b64_tr_b16 a[0:1], v3 offset:24576
    v_mfma_f32_16x16x32_bf16 v[192:195], a[24:27], v[124:127], v[192:195]
    buffer_load_dwordx4 v7, s[12:15], s55 offen lds
    v_mfma_f32_16x16x32_bf16 v[192:195], a[32:35], v[96:99], v[192:195]
    s_waitcnt lgkmcnt(11)
    s_add_u32 m0, s60, 94208
    ds_read_b64_tr_b16 a[2:3], v3 offset:28672
    v_mfma_f32_16x16x32_bf16 v[192:195], a[40:43], v[100:103], v[192:195]
    s_xor_b32 s52, s59, 1216512
    ds_read_b64_tr_b16 a[4:5], v4 offset:24576
    v_mfma_f32_16x16x32_bf16 v[196:199], a[44:47], v[100:103], v[196:199]
    ds_read_b64_tr_b16 a[6:7], v4 offset:28672
    v_mfma_f32_16x16x32_bf16 v[196:199], a[36:39], v[96:99], v[196:199]
    ds_read_b128 v[112:115], v2 offset:53248
    v_mfma_f32_16x16x32_bf16 v[196:199], a[28:31], v[124:127], v[196:199]
    v_mfma_f32_16x16x32_bf16 v[204:207], a[28:31], v[96:99], v[204:207]
    buffer_load_dwordx4 v7, s[12:15], s52 offen lds
    v_mfma_f32_16x16x32_bf16 v[204:207], a[36:39], v[100:103], v[204:207]
    s_waitcnt lgkmcnt(10)
    s_add_u32 m0, s60, 0
    s_xor_b32 s53, s59, 393216
    v_mfma_f32_16x16x32_bf16 v[204:207], a[44:47], v[104:107], v[204:207]
    v_mfma_f32_16x16x32_bf16 v[200:203], a[40:43], v[104:107], v[200:203]
    v_mfma_f32_16x16x32_bf16 v[200:203], a[32:35], v[100:103], v[200:203]
    ds_read_b128 v[116:119], v2 offset:54272
    v_mfma_f32_16x16x32_bf16 v[200:203], a[24:27], v[96:99], v[200:203]
    v_mfma_f32_16x16x32_bf16 v[208:211], a[24:27], v[100:103], v[208:211]
    buffer_load_dwordx4 v7, s[12:15], s53 offen lds
    v_mfma_f32_16x16x32_bf16 v[208:211], a[32:35], v[104:107], v[208:211]
    s_waitcnt lgkmcnt(6)
    s_add_u32 m0, s60, 4096
    s_xor_b32 s54, s59, 397312
    v_mfma_f32_16x16x32_bf16 v[208:211], a[40:43], v[108:111], v[208:211]
    v_mfma_f32_16x16x32_bf16 v[212:215], a[44:47], v[108:111], v[212:215]
    v_mfma_f32_16x16x32_bf16 v[212:215], a[36:39], v[104:107], v[212:215]
    ds_read_b128 v[120:123], v2 offset:55296
    v_mfma_f32_16x16x32_bf16 v[212:215], a[28:31], v[100:103], v[212:215]
    v_mfma_f32_16x16x32_bf16 v[220:223], a[28:31], v[104:107], v[220:223]
    buffer_load_dwordx4 v7, s[12:15], s54 offen lds
    v_mfma_f32_16x16x32_bf16 v[220:223], a[36:39], v[108:111], v[220:223]
    s_waitcnt lgkmcnt(2)
    s_add_u32 m0, s60, 8192
    s_xor_b32 s55, s59, 917504
    v_mfma_f32_16x16x32_bf16 v[220:223], a[44:47], v[112:115], v[220:223]
    v_mfma_f32_16x16x32_bf16 v[216:219], a[40:43], v[112:115], v[216:219]
    v_mfma_f32_16x16x32_bf16 v[216:219], a[32:35], v[108:111], v[216:219]
    s_waitcnt vmcnt(12)
    ds_read_b128 v[124:127], v2 offset:56320
    v_mfma_f32_16x16x32_bf16 v[216:219], a[24:27], v[104:107], v[216:219]
    s_barrier
    ds_read_b64_tr_b16 a[80:81], v5 offset:8192
    v_mfma_f32_16x16x32_bf16 v[224:227], a[24:27], v[108:111], v[224:227]
    buffer_load_dwordx4 v7, s[12:15], s55 offen lds
    v_mfma_f32_16x16x32_bf16 v[224:227], a[32:35], v[112:115], v[224:227]
    s_waitcnt lgkmcnt(3)
    s_add_u32 m0, s60, 12288
    ds_read_b64_tr_b16 a[82:83], v5 offset:12288
    v_mfma_f32_16x16x32_bf16 v[224:227], a[40:43], v[116:119], v[224:227]
    s_xor_b32 s52, s59, 921600
    ds_read_b64_tr_b16 a[84:85], v6 offset:8192
    v_mfma_f32_16x16x32_bf16 v[228:231], a[44:47], v[116:119], v[228:231]
    ds_read_b64_tr_b16 a[86:87], v6 offset:12288
    v_mfma_f32_16x16x32_bf16 v[228:231], a[36:39], v[112:115], v[228:231]
    ds_read_b64_tr_b16 a[88:89], v5 offset:16384
    v_mfma_f32_16x16x32_bf16 v[228:231], a[28:31], v[108:111], v[228:231]
    buffer_load_dwordx4 v7, s[12:15], s52 offen lds
    v_mfma_f32_16x16x32_bf16 v[236:239], a[28:31], v[112:115], v[236:239]
    s_add_u32 m0, s60, 16384
    s_xor_b32 s53, s59, 1441792
    ds_read_b128 v[96:99], v1 offset:0
    v_mfma_f32_16x16x32_bf16 v[236:239], a[36:39], v[116:119], v[236:239]
    s_waitcnt lgkmcnt(7)
    ds_read_b128 v[100:103], v1 offset:1024
    v_mfma_f32_16x16x32_bf16 v[236:239], a[44:47], v[120:123], v[236:239]
    ds_read_b64_tr_b16 a[90:91], v5 offset:20480
    v_mfma_f32_16x16x32_bf16 v[232:235], a[40:43], v[120:123], v[232:235]
    ds_read_b64_tr_b16 a[92:93], v6 offset:16384
    v_mfma_f32_16x16x32_bf16 v[232:235], a[32:35], v[116:119], v[232:235]
    ds_read_b64_tr_b16 a[94:95], v6 offset:20480
    v_mfma_f32_16x16x32_bf16 v[232:235], a[24:27], v[112:115], v[232:235]
    buffer_load_dwordx4 v7, s[12:15], s53 offen lds
    v_mfma_f32_16x16x32_bf16 v[240:243], a[24:27], v[116:119], v[240:243]
    s_add_u32 m0, s60, 20480
    s_xor_b32 s54, s59, 1445888
    ds_read_b128 v[104:107], v1 offset:2048
    v_mfma_f32_16x16x32_bf16 v[240:243], a[32:35], v[120:123], v[240:243]
    s_waitcnt lgkmcnt(11)
    ds_read_b64_tr_b16 a[72:73], v5 offset:0
    v_mfma_f32_16x16x32_bf16 v[240:243], a[40:43], v[124:127], v[240:243]
    ds_read_b64_tr_b16 a[74:75], v5 offset:4096
    v_mfma_f32_16x16x32_bf16 v[244:247], a[44:47], v[124:127], v[244:247]
    ds_read_b64_tr_b16 a[76:77], v6 offset:0
    v_mfma_f32_16x16x32_bf16 v[244:247], a[36:39], v[120:123], v[244:247]
    ds_read_b64_tr_b16 a[78:79], v6 offset:4096
    v_mfma_f32_16x16x32_bf16 v[244:247], a[28:31], v[116:119], v[244:247]
    buffer_load_dwordx4 v7, s[12:15], s54 offen lds
    v_mfma_f32_16x16x32_bf16 v[252:255], a[28:31], v[120:123], v[252:255]
    s_add_u32 m0, s61, 32768
L_stub1:
    s_cbranch_vccnz L_back0
    s_xor_b32 s55, s58, 384
    v_mfma_f32_16x16x32_bf16 v[252:255], a[36:39], v[124:127], v[252:255]
    v_mfma_f32_16x16x32_bf16 v[248:251], a[32:35], v[124:127], v[248:251]
    v_mfma_f32_16x16x32_bf16 v[248:251], a[24:27], v[120:123], v[248:251]
    s_waitcnt lgkmcnt(9)
    ds_read_b128 v[108:111], v1 offset:3072
    v_mfma_f32_16x16x32_bf16 v[128:131], a[8:11], v[96:99], v[128:131]
    s_waitcnt lgkmcnt(9)
    v_mfma_f32_16x16x32_bf16 v[128:131], a[16:19], v[100:103], v[128:131]
    buffer_load_dwordx4 v8, s[8:11], s55 offen offset:0 nt lds
    v_mfma_f32_16x16x32_bf16 v[132:135], a[20:23], v[100:103], v[132:135]
    ds_read_b128 v[112:115], v1 offset:4096
    v_mfma_f32_16x16x32_bf16 v[132:135], a[12:15], v[96:99], v[132:135]
    v_mfma_f32_16x16x32_bf16 v[140:143], a[4:7], v[96:99], v[140:143]
    v_mfma_f32_16x16x32_bf16 v[140:143], a[12:15], v[100:103], v[140:143]
    s_waitcnt lgkmcnt(6)
    v_mfma_f32_16x16x32_bf16 v[140:143], a[20:23], v[104:107], v[140:143]
    buffer_load_dwordx4 v8, s[8:11], s55 offen offset:2048 nt lds
    v_mfma_f32_16x16x32_bf16 v[136:139], a[16:19], v[104:107], v[136:139]
    s_add_u32 m0, s61, 36864
    s_xor_b32 s52, s58, 4480
    v_mfma_f32_16x16x32_bf16 v[136:139], a[8:11], v[100:103], v[136:139]
    ds_read_b128 v[116:119], v1 offset:5120
    v_mfma_f32_16x16x32_bf16 v[136:139], a[0:3], v[96:99], v[136:139]
    v_mfma_f32_16x16x32_bf16 v[144:147], a[0:3], v[100:103], v[144:147]
    v_mfma_f32_16x16x32_bf16 v[144:147], a[8:11], v[104:107], v[144:147]
    s_waitcnt lgkmcnt(2)
    v_mfma_f32_16x16x32_bf16 v[144:147], a[16:19], v[108:111], v[144:147]
    buffer_load_dwordx4 v8, s[8:11], s52 offen offset:0 nt lds
    v_mfma_f32_16x16x32_bf16 v[148:151], a[20:23], v[108:111], v[148:151]
    v_mfma_f32_16x16x32_bf16 v[148:151], a[12:15], v[104:107], v[148:151]
    ds_read_b128 v[120:123], v1 offset:6144
    v_mfma_f32_16x16x32_bf16 v[148:151], a[4:7], v[100:103], v[148:151]
    v_mfma_f32_16x16x32_bf16 v[156:159], a[4:7], v[104:107], v[156:159]
    v_mfma_f32_16x16x32_bf16 v[156:159], a[12:15], v[108:111], v[156:159]
    s_waitcnt lgkmcnt(2)
    v_mfma_f32_16x16x32_bf16 v[156:159], a[20:23], v[112:115], v[156:159]
    buffer_load_dwordx4 v8, s[8:11], s52 offen offset:2048 nt lds
    v_mfma_f32_16x16x32_bf16 v[152:155], a[16:19], v[112:115], v[152:155]
    s_add_u32 m0, s60, 24576
    s_xor_b32 s53, s59, 196608
    v_mfma_f32_16x16x32_bf16 v[152:155], a[8:11], v[108:111], v[152:155]
    ds_read_b128 v[124:127], v1 offset:7168
    v_mfma_f32_16x16x32_bf16 v[152:155], a[0:3], v[104:107], v[152:155]
    v_mfma_f32_16x16x32_bf16 v[160:163], a[0:3], v[108:111], v[160:163]
    v_mfma_f32_16x16x32_bf16 v[160:163], a[8:11], v[112:115], v[160:163]
    s_waitcnt lgkmcnt(2)
    v_mfma_f32_16x16x32_bf16 v[160:163], a[16:19], v[116:119], v[160:163]
    buffer_load_dwordx4 v7, s[12:15], s53 offen lds
    v_mfma_f32_16x16x32_bf16 v[164:167], a[20:23], v[116:119], v[164:167]
    s_add_u32 m0, s60, 28672
    s_xor_b32 s54, s59, 200704
    v_mfma_f32_16x16x32_bf16 v[164:167], a[12:15], v[112:115], v[164:167]
    v_mfma_f32_16x16x32_bf16 v[164:167], a[4:7], v[108:111], v[164:167]
    v_mfma_f32_16x16x32_bf16 v[172:175], a[4:7], v[112:115], v[172:175]
    v_mfma_f32_16x16x32_bf16 v[172:175], a[12:15], v[116:119], v[172:175]
    s_waitcnt lgkmcnt(1)
    v_mfma_f32_16x16x32_bf16 v[172:175], a[20:23], v[120:123], v[172:175]
    buffer_load_dwordx4 v7, s[12:15], s54 offen lds
    v_mfma_f32_16x16x32_bf16 v[168:171], a[16:19], v[120:123], v[168:171]
    s_add_u32 m0, s60, 32768
    s_xor_b32 s55, s59, 720896
    v_mfma_f32_16x16x32_bf16 v[168:171], a[8:11], v[116:119], v[168:171]
    s_waitcnt vmcnt(12)
    v_mfma_f32_16x16x32_bf16 v[168:171], a[0:3], v[112:115], v[168:171]
    s_barrier
    ds_read_b128 v[96:99], v1 offset:16384
    v_mfma_f32_16x16x32_bf16 v[176:179], a[0:3], v[116:119], v[176:179]
    ds_read_b128 v[100:103], v1 offset:17408
    v_mfma_f32_16x16x32_bf16 v[176:179], a[8:11], v[120:123], v[176:179]
    s_waitcnt lgkmcnt(2)
    ds_read_b64_tr_b16 a[32:33], v5 offset:32768
    v_mfma_f32_16x16x32_bf16 v[176:179], a[16:19], v[124:127], v[176:179]
    buffer_load_dwordx4 v7, s[12:15], s55 offen lds
    v_mfma_f32_16x16x32_bf16 v[180:183], a[20:23], v[124:127], v[180:183]
    s_add_u32 m0, s60, 36864
    s_xor_b32 s52, s59, 724992
    ds_read_b64_tr_b16 a[34:35], v5 offset:36864
    v_mfma_f32_16x16x32_bf16 v[180:183], a[12:15], v[120:123], v[180:183]
    ds_read_b128 v[104:107], v1 offset:18432
    v_mfma_f32_16x16x32_bf16 v[180:183], a[4:7], v[116:119], v[180:183]
    ds_read_b64_tr_b16 a[36:37], v6 offset:32768
    v_mfma_f32_16x16x32_bf16 v[188:191], a[4:7], v[120:123], v[188:191]
    ds_read_b64_tr_b16 a[38:39], v6 offset:36864
    v_mfma_f32_16x16x32_bf16 v[188:191], a[12:15], v[124:127], v[188:191]
    s_waitcnt lgkmcnt(6)
    ds_read_b64_tr_b16 a[40:41], v5 offset:40960
    v_mfma_f32_16x16x32_bf16 v[188:191], a[20:23], v[96:99], v[188:191]
    buffer_load_dwordx4 v7, s[12:15], s52 offen lds
    v_mfma_f32_16x16x32_bf16 v[184:187], a[16:19], v[96:99], v[184:187]
    s_add_u32 m0, s60, 40960
    s_xor_b32 s53, s59, 1245184
    ds_read_b64_tr_b16 a[42:43], v5 offset:45056
    v_mfma_f32_16x16x32_bf16 v[184:187], a[8:11], v[124:127], v[184:187]
    ds_read_b128 v[108:111], v1 offset:19456
    v_mfma_f32_16x16x32_bf16 v[184:187], a[0:3], v[120:123], v[184:187]
    ds_read_b64_tr_b16 a[44:45], v6 offset:40960
    v_mfma_f32_16x16x32_bf16 v[192:195], a[0:3], v[124:127], v[192:195]
    ds_read_b64_tr_b16 a[46:47], v6 offset:45056
    v_mfma_f32_16x16x32_bf16 v[192:195], a[8:11], v[96:99], v[192:195]
    s_waitcnt lgkmcnt(10)
    ds_read_b64_tr_b16 a[24:25], v5 offset:24576
    v_mfma_f32_16x16x32_bf16 v[192:195], a[16:19], v[100:103], v[192:195]
    buffer_load_dwordx4 v7, s[12:15], s53 offen lds
    v_mfma_f32_16x16x32_bf16 v[196:199], a[20:23], v[100:103], v[196:199]
    s_add_u32 m0, s60, 45056
    s_xor_b32 s54, s59, 1249280
    ds_read_b64_tr_b16 a[26:27], v5 offset:28672
    v_mfma_f32_16x16x32_bf16 v[196:199], a[12:15], v[96:99], v[196:199]
    ds_read_b128 v[112:115], v1 offset:20480
    v_mfma_f32_16x16x32_bf16 v[196:199], a[4:7], v[124:127], v[196:199]
    ds_read_b64_tr_b16 a[28:29], v6 offset:24576
    v_mfma_f32_16x16x32_bf16 v[204:207], a[4:7], v[96:99], v[204:207]
    ds_read_b64_tr_b16 a[30:31], v6 offset:28672
    v_mfma_f32_16x16x32_bf16 v[204:207], a[12:15], v[100:103], v[204:207]
    s_waitcnt lgkmcnt(12)
    v_mfma_f32_16x16x32_bf16 v[204:207], a[20:23], v[104:107], v[204:207]
    buffer_load_dwordx4 v7, s[12:15], s54 offen lds
    v_mfma_f32_16x16x32_bf16 v[200:203], a[16:19], v[104:107], v[200:203]
    s_add_u32 m0, s60, 49152
    s_xor_b32 s55, s59, 425984
    v_mfma_f32_16x16x32_bf16 v[200:203], a[8:11], v[100:103], v[200:203]
    ds_read_b128 v[116:119], v1 offset:21504
    v_mfma_f32_16x16x32_bf16 v[200:203], a[0:3], v[96:99], v[200:203]
    v_mfma_f32_16x16x32_bf16 v[208:211], a[0:3], v[100:103], v[208:211]
    v_mfma_f32_16x16x32_bf16 v[208:211], a[8:11], v[104:107], v[208:211]
    s_waitcnt lgkmcnt(8)
    v_mfma_f32_16x16x32_bf16 v[208:211], a[16:19], v[108:111], v[208:211]
    buffer_load_dwordx4 v7, s[12:15], s55 offen lds
    v_mfma_f32_16x16x32_bf16 v[212:215], a[20:23], v[108:111], v[212:215]
    s_add_u32 m0, s60, 53248
    s_xor_b32 s52, s59, 430080
    v_mfma_f32_16x16x32_bf16 v[212:215], a[12:15], v[104:107], v[212:215]
    ds_read_b128 v[120:123], v1 offset:22528
    v_mfma_f32_16x16x32_bf16 v[212:215], a[4:7], v[100:103], v[212:215]
    v_mfma_f32_16x16x32_bf16 v[220:223], a[4:7], v[104:107], v[220:223]
    v_mfma_f32_16x16x32_bf16 v[220:223], a[12:15], v[108:111], v[220:223]
    s_waitcnt lgkmcnt(4)
    v_mfma_f32_16x16x32_bf16 v[220:223], a[20:23], v[112:115], v[220:223]
    buffer_load_dwordx4 v7, s[12:15], s52 offen lds
    v_mfma_f32_16x16x32_bf16 v[216:219], a[16:19], v[112:115], v[216:219]
    s_add_u32 m0, s60, 57344
    s_xor_b32 s53, s59, 950272
    v_mfma_f32_16x16x32_bf16 v[216:219], a[8:11], v[108:111], v[216:219]
    s_waitcnt vmcnt(12) lgkmcnt(2)
    ds_read_b128 v[124:127], v1 offset:23552
    v_mfma_f32_16x16x32_bf16 v[216:219], a[0:3], v[104:107], v[216:219]
    s_barrier
    ds_read_b64_tr_b16 a[104:105], v3 offset:8192
    v_mfma_f32_16x16x32_bf16 v[224:227], a[0:3], v[108:111], v[224:227]
    ds_read_b64_tr_b16 a[106:107], v3 offset:12288
    v_mfma_f32_16x16x32_bf16 v[224:227], a[8:11], v[112:115], v[224:227]
    s_waitcnt lgkmcnt(4)
    ds_read_b64_tr_b16 a[108:109], v4 offset:8192
    v_mfma_f32_16x16x32_bf16 v[224:227], a[16:19], v[116:119], v[224:227]
    buffer_load_dwordx4 v7, s[12:15], s53 offen lds
    v_mfma_f32_16x16x32_bf16 v[228:231], a[20:23], v[116:119], v[228:231]
    s_add_u32 m0, s60, 61440
    s_xor_b32 s54, s59, 954368
    ds_read_b64_tr_b16 a[110:111], v4 offset:12288
    v_mfma_f32_16x16x32_bf16 v[228:231], a[12:15], v[112:115], v[228:231]
    ds_read_b64_tr_b16 a[112:113], v3 offset:16384
    v_mfma_f32_16x16x32_bf16 v[228:231], a[4:7], v[108:111], v[228:231]
    ds_read_b64_tr_b16 a[114:115], v3 offset:20480
    v_mfma_f32_16x16x32_bf16 v[236:239], a[4:7], v[112:115], v[236:239]
    ds_read_b128 v[96:99], v2 offset:0
    v_mfma_f32_16x16x32_bf16 v[236:239], a[12:15], v[116:119], v[236:239]
    s_waitcnt lgkmcnt(8)
    ds_read_b128 v[100:103], v2 offset:1024
    v_mfma_f32_16x16x32_bf16 v[236:239], a[20:23], v[120:123], v[236:239]
    buffer_load_dwordx4 v7, s[12:15], s54 offen lds
    v_mfma_f32_16x16x32_bf16 v[232:235], a[16:19], v[120:123], v[232:235]
    s_add_u32 m0, s60, 65536
    s_xor_b32 s55, s59, 1474560
    ds_read_b64_tr_b16 a[116:117], v4 offset:16384
    v_mfma_f32_16x16x32_bf16 v[232:235], a[8:11], v[116:119], v[232:235]
    ds_read_b64_tr_b16 a[118:119], v4 offset:20480
    v_mfma_f32_16x16x32_bf16 v[232:235], a[0:3], v[112:115], v[232:235]
    ds_read_b64_tr_b16 a[96:97], v3 offset:0
    v_mfma_f32_16x16x32_bf16 v[240:243], a[0:3], v[116:119], v[240:243]
    ds_read_b128 v[104:107], v2 offset:2048
    v_mfma_f32_16x16x32_bf16 v[240:243], a[8:11], v[120:123], v[240:243]
    s_waitcnt lgkmcnt(12)
    ds_read_b64_tr_b16 a[98:99], v3 offset:4096
    v_mfma_f32_16x16x32_bf16 v[240:243], a[16:19], v[124:127], v[240:243]
    buffer_load_dwordx4 v7, s[12:15], s55 offen lds
    v_mfma_f32_16x16x32_bf16 v[244:247], a[20:23], v[124:127], v[244:247]
    s_add_u32 m0, s60, 69632
    s_xor_b32 s52, s59, 1478656
    ds_read_b64_tr_b16 a[100:101], v4 offset:0
    v_mfma_f32_16x16x32_bf16 v[244:247], a[12:15], v[120:123], v[244:247]
    ds_read_b64_tr_b16 a[102:103], v4 offset:4096
    v_mfma_f32_16x16x32_bf16 v[244:247], a[4:7], v[116:119], v[244:247]
    v_mfma_f32_16x16x32_bf16 v[252:255], a[4:7], v[120:123], v[252:255]
    v_mfma_f32_16x16x32_bf16 v[252:255], a[12:15], v[124:127], v[252:255]
    buffer_load_dwordx4 v7, s[12:15], s52 offen lds
    v_mfma_f32_16x16x32_bf16 v[248:251], a[8:11], v[124:127], v[248:251]
    s_add_u32 m0, s61, 49152
    s_xor_b32 s53, s58, 8576
    v_mfma_f32_16x16x32_bf16 v[248:251], a[0:3], v[120:123], v[248:251]
    s_waitcnt lgkmcnt(8)
    ds_read_b128 v[108:111], v2 offset:3072
    v_mfma_f32_16x16x32_bf16 v[128:131], a[32:35], v[96:99], v[128:131]
    s_waitcnt lgkmcnt(8)
    v_mfma_f32_16x16x32_bf16 v[128:131], a[40:43], v[100:103], v[128:131]
    v_mfma_f32_16x16x32_bf16 v[132:135], a[44:47], v[100:103], v[132:135]
    ds_read_b128 v[112:115], v2 offset:4096
    v_mfma_f32_16x16x32_bf16 v[132:135], a[36:39], v[96:99], v[132:135]
    buffer_load_dwordx4 v8, s[8:11], s53 offen offset:0 nt lds
    v_mfma_f32_16x16x32_bf16 v[140:143], a[28:31], v[96:99], v[140:143]
    v_mfma_f32_16x16x32_bf16 v[140:143], a[36:39], v[100:103], v[140:143]
    s_waitcnt lgkmcnt(5)
    v_mfma_f32_16x16x32_bf16 v[140:143], a[44:47], v[104:107], v[140:143]
    v_mfma_f32_16x16x32_bf16 v[136:139], a[40:43], v[104:107], v[136:139]
    v_mfma_f32_16x16x32_bf16 v[136:139], a[32:35], v[100:103], v[136:139]
    ds_read_b128 v[116:119], v2 offset:5120
    v_mfma_f32_16x16x32_bf16 v[136:139], a[24:27], v[96:99], v[136:139]
    buffer_load_dwordx4 v8, s[8:11], s53 offen offset:2048 nt lds
    v_mfma_f32_16x16x32_bf16 v[144:147], a[24:27], v[100:103], v[144:147]
    s_add_u32 m0, s61, 53248
    s_xor_b32 s54, s58, 12672
    v_mfma_f32_16x16x32_bf16 v[144:147], a[32:35], v[104:107], v[144:147]
    s_waitcnt lgkmcnt(2)
    v_mfma_f32_16x16x32_bf16 v[144:147], a[40:43], v[108:111], v[144:147]
    v_mfma_f32_16x16x32_bf16 v[148:151], a[44:47], v[108:111], v[148:151]
    v_mfma_f32_16x16x32_bf16 v[148:151], a[36:39], v[104:107], v[148:151]
    ds_read_b128 v[120:123], v2 offset:6144
    v_mfma_f32_16x16x32_bf16 v[148:151], a[28:31], v[100:103], v[148:151]
    buffer_load_dwordx4 v8, s[8:11], s54 offen offset:0 nt lds
    v_mfma_f32_16x16x32_bf16 v[156:159], a[28:31], v[104:107], v[156:159]
    v_mfma_f32_16x16x32_bf16 v[156:159], a[36:39], v[108:111], v[156:159]
    s_waitcnt lgkmcnt(2)
    v_mfma_f32_16x16x32_bf16 v[156:159], a[44:47], v[112:115], v[156:159]
    v_mfma_f32_16x16x32_bf16 v[152:155], a[40:43], v[112:115], v[152:155]
    v_mfma_f32_16x16x32_bf16 v[152:155], a[32:35], v[108:111], v[152:155]
    buffer_load_dwordx4 v8, s[8:11], s54 offen offset:2048 nt lds
    v_mfma_f32_16x16x32_bf16 v[152:155], a[24:27], v[104:107], v[152:155]
    s_add_u32 m0, s60, 73728
    s_xor_b32 s55, s59, 229376
    ds_read_b128 v[124:127], v2 offset:7168
    v_mfma_f32_16x16x32_bf16 v[160:163], a[24:27], v[108:111], v[160:163]
    v_mfma_f32_16x16x32_bf16 v[160:163], a[32:35], v[112:115], v[160:163]
    s_waitcnt lgkmcnt(2)
    v_mfma_f32_16x16x32_bf16 v[160:163], a[40:43], v[116:119], v[160:163]
    v_mfma_f32_16x16x32_bf16 v[164:167], a[44:47], v[116:119], v[164:167]
    v_mfma_f32_16x16x32_bf16 v[164:167], a[36:39], v[112:115], v[164:167]
    buffer_load_dwordx4 v7, s[12:15], s55 offen lds
    v_mfma_f32_16x16x32_bf16 v[164:167], a[28:31], v[108:111], v[164:167]
    s_add_u32 m0, s60, 77824
    s_xor_b32 s52, s59, 233472
    ds_read_b128 v[96:99], v2 offset:16384
    v_mfma_f32_16x16x32_bf16 v[172:175], a[28:31], v[112:115], v[172:175]
    v_mfma_f32_16x16x32_bf16 v[172:175], a[36:39], v[116:119], v[172:175]
    s_waitcnt lgkmcnt(2)
    v_mfma_f32_16x16x32_bf16 v[172:175], a[44:47], v[120:123], v[172:175]
    v_mfma_f32_16x16x32_bf16 v[168:171], a[40:43], v[120:123], v[168:171]
    v_mfma_f32_16x16x32_bf16 v[168:171], a[32:35], v[116:119], v[168:171]
    s_waitcnt vmcnt(11) lgkmcnt(1)
    ds_read_b128 v[100:103], v2 offset:17408
    v_mfma_f32_16x16x32_bf16 v[168:171], a[24:27], v[112:115], v[168:171]
    s_barrier
    ds_read_b64_tr_b16 a[8:9], v3 offset:32768
    v_mfma_f32_16x16x32_bf16 v[176:179], a[24:27], v[116:119], v[176:179]
    buffer_load_dwordx4 v7, s[12:15], s52 offen lds
    v_mfma_f32_16x16x32_bf16 v[176:179], a[32:35], v[120:123], v[176:179]
    s_add_u32 m0, s60, 81920
    s_xor_b32 s53, s59, 753664
    ds_read_b64_tr_b16 a[10:11], v3 offset:36864
    v_mfma_f32_16x16x32_bf16 v[176:179], a[40:43], v[124:127], v[176:179]
    ds_read_b64_tr_b16 a[12:13], v4 offset:32768
    v_mfma_f32_16x16x32_bf16 v[180:183], a[44:47], v[124:127], v[180:183]
    ds_read_b64_tr_b16 a[14:15], v4 offset:36864
    v_mfma_f32_16x16x32_bf16 v[180:183], a[36:39], v[120:123], v[180:183]
    ds_read_b128 v[104:107], v2 offset:18432
    v_mfma_f32_16x16x32_bf16 v[180:183], a[28:31], v[116:119], v[180:183]
    ds_read_b64_tr_b16 a[16:17], v3 offset:40960
    v_mfma_f32_16x16x32_bf16 v[188:191], a[28:31], v[120:123], v[188:191]
    buffer_load_dwordx4 v7, s[12:15], s53 offen lds
    v_mfma_f32_16x16x32_bf16 v[188:191], a[36:39], v[124:127], v[188:191]
    s_waitcnt lgkmcnt(7)
    s_add_u32 m0, s60, 86016
    ds_read_b64_tr_b16 a[18:19], v3 offset:45056
    v_mfma_f32_16x16x32_bf16 v[188:191], a[44:47], v[96:99], v[188:191]
    s_xor_b32 s54, s59, 757760
    ds_read_b64_tr_b16 a[20:21], v4 offset:40960
    v_mfma_f32_16x16x32_bf16 v[184:187], a[40:43], v[96:99], v[184:187]
    ds_read_b64_tr_b16 a[22:23], v4 offset:45056
    v_mfma_f32_16x16x32_bf16 v[184:187], a[32:35], v[124:127], v[184:187]
    ds_read_b128 v[108:111], v2 offset:19456
    v_mfma_f32_16x16x32_bf16 v[184:187], a[24:27], v[120:123], v[184:187]
    ds_read_b64_tr_b16 a[0:1], v3 offset:24576
    v_mfma_f32_16x16x32_bf16 v[192:195], a[24:27], v[124:127], v[192:195]
    buffer_load_dwordx4 v7, s[12:15], s54 offen lds
    v_mfma_f32_16x16x32_bf16 v[192:195], a[32:35], v[96:99], v[192:195]
    s_waitcnt lgkmcnt(11)
    s_add_u32 m0, s60, 90112
    ds_read_b64_tr_b16 a[2:3], v3 offset:28672
    v_mfma_f32_16x16x32_bf16 v[192:195], a[40:43], v[100:103], v[192:195]
    s_xor_b32 s55, s59, 1277952
    ds_read_b64_tr_b16 a[4:5], v4 offset:24576
    v_mfma_f32_16x16x32_bf16 v[196:199], a[44:47], v[100:103], v[196:199]
    ds_read_b64_tr_b16 a[6:7], v4 offset:28672
    v_mfma_f32_16x16x32_bf16 v[196:199], a[36:39], v[96:99], v[196:199]
    ds_read_b128 v[112:115], v2 offset:20480
    v_mfma_f32_16x16x32_bf16 v[196:199], a[28:31], v[124:127], v[196:199]
    v_mfma_f32_16x16x32_bf16 v[204:207], a[28:31], v[96:99], v[204:207]
    buffer_load_dwordx4 v7, s[12:15], s55 offen lds
    v_mfma_f32_16x16x32_bf16 v[204:207], a[36:39], v[100:103], v[204:207]
    s_waitcnt lgkmcnt(10)
    s_add_u32 m0, s60, 94208
    s_xor_b32 s52, s59, 1282048
    v_mfma_f32_16x16x32_bf16 v[204:207], a[44:47], v[104:107], v[204:207]
    v_mfma_f32_16x16x32_bf16 v[200:203], a[40:43], v[104:107], v[200:203]
    v_mfma_f32_16x16x32_bf16 v[200:203], a[32:35], v[100:103], v[200:203]
    ds_read_b128 v[116:119], v2 offset:21504
    v_mfma_f32_16x16x32_bf16 v[200:203], a[24:27], v[96:99], v[200:203]
    v_mfma_f32_16x16x32_bf16 v[208:211], a[24:27], v[100:103], v[208:211]
    buffer_load_dwordx4 v7, s[12:15], s52 offen lds
    v_mfma_f32_16x16x32_bf16 v[208:211], a[32:35], v[104:107], v[208:211]
    s_waitcnt lgkmcnt(6)
    s_add_u32 m0, s60, 0
    s_xor_b32 s53, s59, 458752
    v_mfma_f32_16x16x32_bf16 v[208:211], a[40:43], v[108:111], v[208:211]
    v_mfma_f32_16x16x32_bf16 v[212:215], a[44:47], v[108:111], v[212:215]
    v_mfma_f32_16x16x32_bf16 v[212:215], a[36:39], v[104:107], v[212:215]
    ds_read_b128 v[120:123], v2 offset:22528
    v_mfma_f32_16x16x32_bf16 v[212:215], a[28:31], v[100:103], v[212:215]
    buffer_load_dwordx4 v7, s[12:15], s53 offen lds
    v_mfma_f32_16x16x32_bf16 v[220:223], a[28:31], v[104:107], v[220:223]
    s_add_u32 m0, s60, 4096
    s_xor_b32 s54, s59, 462848
    v_mfma_f32_16x16x32_bf16 v[220:223], a[36:39], v[108:111], v[220:223]
    s_waitcnt lgkmcnt(2)
    v_mfma_f32_16x16x32_bf16 v[220:223], a[44:47], v[112:115], v[220:223]
    v_mfma_f32_16x16x32_bf16 v[216:219], a[40:43], v[112:115], v[216:219]
    v_mfma_f32_16x16x32_bf16 v[216:219], a[32:35], v[108:111], v[216:219]
    s_waitcnt vmcnt(11)
    ds_read_b128 v[124:127], v2 offset:23552
    v_mfma_f32_16x16x32_bf16 v[216:219], a[24:27], v[104:107], v[216:219]
    s_barrier
    ds_read_b64_tr_b16 a[128:129], v5 offset:8192
    v_mfma_f32_16x16x32_bf16 v[224:227], a[24:27], v[108:111], v[224:227]
    buffer_load_dwordx4 v7, s[12:15], s54 offen lds
    v_mfma_f32_16x16x32_bf16 v[224:227], a[32:35], v[112:115], v[224:227]
    s_waitcnt lgkmcnt(3)
    s_add_u32 m0, s60, 8192
    ds_read_b64_tr_b16 a[130:131], v5 offset:12288
    v_mfma_f32_16x16x32_bf16 v[224:227], a[40:43], v[116:119], v[224:227]
    s_xor_b32 s55, s59, 983040
    ds_read_b64_tr_b16 a[132:133], v6 offset:8192
    v_mfma_f32_16x16x32_bf16 v[228:231], a[44:47], v[116:119], v[228:231]
    ds_read_b64_tr_b16 a[134:135], v6 offset:12288
    v_mfma_f32_16x16x32_bf16 v[228:231], a[36:39], v[112:115], v[228:231]
    ds_read_b64_tr_b16 a[136:137], v5 offset:16384
    v_mfma_f32_16x16x32_bf16 v[228:231], a[28:31], v[108:111], v[228:231]
    buffer_load_dwordx4 v7, s[12:15], s55 offen lds
    v_mfma_f32_16x16x32_bf16 v[236:239], a[28:31], v[112:115], v[236:239]
    s_add_u32 m0, s60, 12288
    s_xor_b32 s52, s59, 987136
    ds_read_b128 v[96:99], v1 offset:32768
    v_mfma_f32_16x16x32_bf16 v[236:239], a[36:39], v[116:119], v[236:239]
    s_waitcnt lgkmcnt(7)
    ds_read_b128 v[100:103], v1 offset:33792
    v_mfma_f32_16x16x32_bf16 v[236:239], a[44:47], v[120:123], v[236:239]
    ds_read_b64_tr_b16 a[138:139], v5 offset:20480
    v_mfma_f32_16x16x32_bf16 v[232:235], a[40:43], v[120:123], v[232:235]
    ds_read_b64_tr_b16 a[140:141], v6 offset:16384
    v_mfma_f32_16x16x32_bf16 v[232:235], a[32:35], v[116:119], v[232:235]
    ds_read_b64_tr_b16 a[142:143], v6 offset:20480
    v_mfma_f32_16x16x32_bf16 v[232:235], a[24:27], v[112:115], v[232:235]
    buffer_load_dwordx4 v7, s[12:15], s52 offen lds
    v_mfma_f32_16x16x32_bf16 v[240:243], a[24:27], v[116:119], v[240:243]
    s_add_u32 m0, s60, 16384
    s_xor_b32 s53, s59, 1507328
    ds_read_b128 v[104:107], v1 offset:34816
    v_mfma_f32_16x16x32_bf16 v[240:243], a[32:35], v[120:123], v[240:243]
    s_waitcnt lgkmcnt(11)
    ds_read_b64_tr_b16 a[120:121], v5 offset:0
    v_mfma_f32_16x16x32_bf16 v[240:243], a[40:43], v[124:127], v[240:243]
    ds_read_b64_tr_b16 a[122:123], v5 offset:4096
    v_mfma_f32_16x16x32_bf16 v[244:247], a[44:47], v[124:127], v[244:247]
    ds_read_b64_tr_b16 a[124:125], v6 offset:0
    v_mfma_f32_16x16x32_bf16 v[244:247], a[36:39], v[120:123], v[244:247]
    ds_read_b64_tr_b16 a[126:127], v6 offset:4096
    v_mfma_f32_16x16x32_bf16 v[244:247], a[28:31], v[116:119], v[244:247]
    buffer_load_dwordx4 v7, s[12:15], s53 offen lds
    v_mfma_f32_16x16x32_bf16 v[252:255], a[28:31], v[120:123], v[252:255]
    s_add_u32 m0, s60, 20480
    s_xor_b32 s54, s59, 1511424
    v_mfma_f32_16x16x32_bf16 v[252:255], a[36:39], v[124:127], v[252:255]
    v_mfma_f32_16x16x32_bf16 v[248:251], a[32:35], v[124:127], v[248:251]
    v_mfma_f32_16x16x32_bf16 v[248:251], a[24:27], v[120:123], v[248:251]
    s_waitcnt lgkmcnt(9)
    ds_read_b128 v[108:111], v1 offset:35840
    v_mfma_f32_16x16x32_bf16 v[128:131], a[8:11], v[96:99], v[128:131]
    s_waitcnt lgkmcnt(9)
    v_mfma_f32_16x16x32_bf16 v[128:131], a[16:19], v[100:103], v[128:131]
    buffer_load_dwordx4 v7, s[12:15], s54 offen lds
    v_mfma_f32_16x16x32_bf16 v[132:135], a[20:23], v[100:103], v[132:135]
    s_add_u32 m0, s61, 0
    s_xor_b32 s55, s58, 512
    ds_read_b128 v[112:115], v1 offset:36864
    v_mfma_f32_16x16x32_bf16 v[132:135], a[12:15], v[96:99], v[132:135]
    v_mfma_f32_16x16x32_bf16 v[140:143], a[4:7], v[96:99], v[140:143]
    v_mfma_f32_16x16x32_bf16 v[140:143], a[12:15], v[100:103], v[140:143]
    s_waitcnt lgkmcnt(6)
    v_mfma_f32_16x16x32_bf16 v[140:143], a[20:23], v[104:107], v[140:143]
    buffer_load_dwordx4 v8, s[8:11], s55 offen offset:0 nt lds
    v_mfma_f32_16x16x32_bf16 v[136:139], a[16:19], v[104:107], v[136:139]
    v_mfma_f32_16x16x32_bf16 v[136:139], a[8:11], v[100:103], v[136:139]
    ds_read_b128 v[116:119], v1 offset:37888
    v_mfma_f32_16x16x32_bf16 v[136:139], a[0:3], v[96:99], v[136:139]
    v_mfma_f32_16x16x32_bf16 v[144:147], a[0:3], v[100:103], v[144:147]
    v_mfma_f32_16x16x32_bf16 v[144:147], a[8:11], v[104:107], v[144:147]
    s_waitcnt lgkmcnt(2)
    v_mfma_f32_16x16x32_bf16 v[144:147], a[16:19], v[108:111], v[144:147]
    buffer_load_dwordx4 v8, s[8:11], s55 offen offset:2048 nt lds
    v_mfma_f32_16x16x32_bf16 v[148:151], a[20:23], v[108:111], v[148:151]
    s_add_u32 m0, s61, 4096
    s_xor_b32 s52, s58, 4608
    v_mfma_f32_16x16x32_bf16 v[148:151], a[12:15], v[104:107], v[148:151]
    ds_read_b128 v[120:123], v1 offset:38912
    v_mfma_f32_16x16x32_bf16 v[148:151], a[4:7], v[100:103], v[148:151]
    v_mfma_f32_16x16x32_bf16 v[156:159], a[4:7], v[104:107], v[156:159]
    v_mfma_f32_16x16x32_bf16 v[156:159], a[12:15], v[108:111], v[156:159]
    s_waitcnt lgkmcnt(2)
    v_mfma_f32_16x16x32_bf16 v[156:159], a[20:23], v[112:115], v[156:159]
    buffer_load_dwordx4 v8, s[8:11], s52 offen offset:0 nt lds
    v_mfma_f32_16x16x32_bf16 v[152:155], a[16:19], v[112:115], v[152:155]
    v_mfma_f32_16x16x32_bf16 v[152:155], a[8:11], v[108:111], v[152:155]
    ds_read_b128 v[124:127], v1 offset:39936
    v_mfma_f32_16x16x32_bf16 v[152:155], a[0:3], v[104:107], v[152:155]
    v_mfma_f32_16x16x32_bf16 v[160:163], a[0:3], v[108:111], v[160:163]
    v_mfma_f32_16x16x32_bf16 v[160:163], a[8:11], v[112:115], v[160:163]
    s_waitcnt lgkmcnt(2)
    v_mfma_f32_16x16x32_bf16 v[160:163], a[16:19], v[116:119], v[160:163]
    buffer_load_dwordx4 v8, s[8:11], s52 offen offset:2048 nt lds
    v_mfma_f32_16x16x32_bf16 v[164:167], a[20:23], v[116:119], v[164:167]
    s_add_u32 m0, s60, 24576
    s_xor_b32 s53, s59, 262144
    v_mfma_f32_16x16x32_bf16 v[164:167], a[12:15], v[112:115], v[164:167]
    v_mfma_f32_16x16x32_bf16 v[164:167], a[4:7], v[108:111], v[164:167]
    v_mfma_f32_16x16x32_bf16 v[172:175], a[4:7], v[112:115], v[172:175]
    v_mfma_f32_16x16x32_bf16 v[172:175], a[12:15], v[116:119], v[172:175]
    s_waitcnt lgkmcnt(1)
    v_mfma_f32_16x16x32_bf16 v[172:175], a[20:23], v[120:123], v[172:175]
    buffer_load_dwordx4 v7, s[12:15], s53 offen lds
    v_mfma_f32_16x16x32_bf16 v[168:171], a[16:19], v[120:123], v[168:171]
    s_add_u32 m0, s60, 28672
    s_xor_b32 s54, s59, 266240
    v_mfma_f32_16x16x32_bf16 v[168:171], a[8:11], v[116:119], v[168:171]
    s_waitcnt vmcnt(11)
    v_mfma_f32_16x16x32_bf16 v[168:171], a[0:3], v[112:115], v[168:171]
    s_barrier
    ds_read_b128 v[96:99], v1 offset:49152
    v_mfma_f32_16x16x32_bf16 v[176:179], a[0:3], v[116:119], v[176:179]
    ds_read_b128 v[100:103], v1 offset:50176
    v_mfma_f32_16x16x32_bf16 v[176:179], a[8:11], v[120:123], v[176:179]
    s_waitcnt lgkmcnt(2)
    ds_read_b64_tr_b16 a[32:33], v5 offset:32768
    v_mfma_f32_16x16x32_bf16 v[176:179], a[16:19], v[124:127], v[176:179]
    buffer_load_dwordx4 v7, s[12:15], s54 offen lds
    v_mfma_f32_16x16x32_bf16 v[180:183], a[20:23], v[124:127], v[180:183]
    s_add_u32 m0, s60, 32768
    s_xor_b32 s55, s59, 786432
    ds_read_b64_tr_b16 a[34:35], v5 offset:36864
    v_mfma_f32_16x16x32_bf16 v[180:183], a[12:15], v[120:123], v[180:183]
    ds_read_b128 v[104:107], v1 offset:51200
    v_mfma_f32_16x16x32_bf16 v[180:183], a[4:7], v[116:119], v[180:183]
    ds_read_b64_tr_b16 a[36:37], v6 offset:32768
    v_mfma_f32_16x16x32_bf16 v[188:191], a[4:7], v[120:123], v[188:191]
    ds_read_b64_tr_b16 a[38:39], v6 offset:36864
    v_mfma_f32_16x16x32_bf16 v[188:191], a[12:15], v[124:127], v[188:191]
    s_waitcnt lgkmcnt(6)
    ds_read_b64_tr_b16 a[40:41], v5 offset:40960
    v_mfma_f32_16x16x32_bf16 v[188:191], a[20:23], v[96:99], v[188:191]
    buffer_load_dwordx4 v7, s[12:15], s55 offen lds
    v_mfma_f32_16x16x32_bf16 v[184:187], a[16:19], v[96:99], v[184:187]
    s_add_u32 m0, s60, 36864
    s_xor_b32 s52, s59, 790528
    ds_read_b64_tr_b16 a[42:43], v5 offset:45056
    v_mfma_f32_16x16x32_bf16 v[184:187], a[8:11], v[124:127], v[184:187]
    ds_read_b128 v[108:111], v1 offset:52224
    v_mfma_f32_16x16x32_bf16 v[184:187], a[0:3], v[120:123], v[184:187]
    ds_read_b64_tr_b16 a[44:45], v6 offset:40960
    v_mfma_f32_16x16x32_bf16 v[192:195], a[0:3], v[124:127], v[192:195]
    ds_read_b64_tr_b16 a[46:47], v6 offset:45056
    v_mfma_f32_16x16x32_bf16 v[192:195], a[8:11], v[96:99], v[192:195]
    s_waitcnt lgkmcnt(10)
    ds_read_b64_tr_b16 a[24:25], v5 offset:24576
    v_mfma_f32_16x16x32_bf16 v[192:195], a[16:19], v[100:103], v[192:195]
    buffer_load_dwordx4 v7, s[12:15], s52 offen lds
    v_mfma_f32_16x16x32_bf16 v[196:199], a[20:23], v[100:103], v[196:199]
    s_add_u32 m0, s60, 40960
    s_xor_b32 s53, s59, 1310720
    ds_read_b64_tr_b16 a[26:27], v5 offset:28672
    v_mfma_f32_16x16x32_bf16 v[196:199], a[12:15], v[96:99], v[196:199]
    ds_read_b128 v[112:115], v1 offset:53248
    v_mfma_f32_16x16x32_bf16 v[196:199], a[4:7], v[124:127], v[196:199]
    ds_read_b64_tr_b16 a[28:29], v6 offset:24576
    v_mfma_f32_16x16x32_bf16 v[204:207], a[4:7], v[96:99], v[204:207]
    ds_read_b64_tr_b16 a[30:31], v6 offset:28672
    v_mfma_f32_16x16x32_bf16 v[204:207], a[12:15], v[100:103], v[204:207]
    s_waitcnt lgkmcnt(12)
    v_mfma_f32_16x16x32_bf16 v[204:207], a[20:23], v[104:107], v[204:207]
    buffer_load_dwordx4 v7, s[12:15], s53 offen lds
    v_mfma_f32_16x16x32_bf16 v[200:203], a[16:19], v[104:107], v[200:203]
    s_add_u32 m0, s60, 45056
    s_xor_b32 s54, s59, 1314816
    v_mfma_f32_16x16x32_bf16 v[200:203], a[8:11], v[100:103], v[200:203]
    ds_read_b128 v[116:119], v1 offset:54272
    v_mfma_f32_16x16x32_bf16 v[200:203], a[0:3], v[96:99], v[200:203]
    v_mfma_f32_16x16x32_bf16 v[208:211], a[0:3], v[100:103], v[208:211]
    v_mfma_f32_16x16x32_bf16 v[208:211], a[8:11], v[104:107], v[208:211]
    s_waitcnt lgkmcnt(8)
    v_mfma_f32_16x16x32_bf16 v[208:211], a[16:19], v[108:111], v[208:211]
    buffer_load_dwordx4 v7, s[12:15], s54 offen lds
    v_mfma_f32_16x16x32_bf16 v[212:215], a[20:23], v[108:111], v[212:215]
    s_add_u32 m0, s60, 49152
    s_xor_b32 s55, s59, 491520
    v_mfma_f32_16x16x32_bf16 v[212:215], a[12:15], v[104:107], v[212:215]
    ds_read_b128 v[120:123], v1 offset:55296
    v_mfma_f32_16x16x32_bf16 v[212:215], a[4:7], v[100:103], v[212:215]
    v_mfma_f32_16x16x32_bf16 v[220:223], a[4:7], v[104:107], v[220:223]
    v_mfma_f32_16x16x32_bf16 v[220:223], a[12:15], v[108:111], v[220:223]
    s_waitcnt lgkmcnt(4)
    v_mfma_f32_16x16x32_bf16 v[220:223], a[20:23], v[112:115], v[220:223]
    buffer_load_dwordx4 v7, s[12:15], s55 offen lds
    v_mfma_f32_16x16x32_bf16 v[216:219], a[16:19], v[112:115], v[216:219]
    s_add_u32 m0, s60, 53248
    s_xor_b32 s52, s59, 495616
    v_mfma_f32_16x16x32_bf16 v[216:219], a[8:11], v[108:111], v[216:219]
    s_waitcnt vmcnt(11) lgkmcnt(2)
    ds_read_b128 v[124:127], v1 offset:56320
    v_mfma_f32_16x16x32_bf16 v[216:219], a[0:3], v[104:107], v[216:219]
    s_barrier
    ds_read_b64_tr_b16 a[152:153], v3 offset:8192
    v_mfma_f32_16x16x32_bf16 v[224:227], a[0:3], v[108:111], v[224:227]
    ds_read_b64_tr_b16 a[154:155], v3 offset:12288
    v_mfma_f32_16x16x32_bf16 v[224:227], a[8:11], v[112:115], v[224:227]
    s_waitcnt lgkmcnt(4)
L_stub2:
    s_cbranch_vccnz L_back0
    ds_read_b64_tr_b16 a[156:157], v4 offset:8192
    v_mfma_f32_16x16x32_bf16 v[224:227], a[16:19], v[116:119], v[224:227]
    buffer_load_dwordx4 v7, s[12:15], s52 offen lds
    v_mfma_f32_16x16x32_bf16 v[228:231], a[20:23], v[116:119], v[228:231]
    s_add_u32 m0, s60, 57344
    s_xor_b32 s53, s59, 1015808
    ds_read_b64_tr_b16 a[158:159], v4 offset:12288
    v_mfma_f32_16x16x32_bf16 v[228:231], a[12:15], v[112:115], v[228:231]
    ds_read_b64_tr_b16 a[160:161], v3 offset:16384
    v_mfma_f32_16x16x32_bf16 v[228:231], a[4:7], v[108:111], v[228:231]
    ds_read_b64_tr_b16 a[162:163], v3 offset:20480
    v_mfma_f32_16x16x32_bf16 v[236:239], a[4:7], v[112:115], v[236:239]
    ds_read_b128 v[96:99], v2 offset:32768
    v_mfma_f32_16x16x32_bf16 v[236:239], a[12:15], v[116:119], v[236:239]
    s_waitcnt lgkmcnt(8)
    ds_read_b128 v[100:103], v2 offset:33792
    v_mfma_f32_16x16x32_bf16 v[236:239], a[20:23], v[120:123], v[236:239]
    buffer_load_dwordx4 v7, s[12:15], s53 offen lds
    v_mfma_f32_16x16x32_bf16 v[232:235], a[16:19], v[120:123], v[232:235]
    s_add_u32 m0, s60, 61440
    s_xor_b32 s54, s59, 1019904
    ds_read_b64_tr_b16 a[164:165], v4 offset:16384
    v_mfma_f32_16x16x32_bf16 v[232:235], a[8:11], v[116:119], v[232:235]
    ds_read_b64_tr_b16 a[166:167], v4 offset:20480
    v_mfma_f32_16x16x32_bf16 v[232:235], a[0:3], v[112:115], v[232:235]
    ds_read_b64_tr_b16 a[144:145], v3 offset:0
    v_mfma_f32_16x16x32_bf16 v[240:243], a[0:3], v[116:119], v[240:243]
    ds_read_b128 v[104:107], v2 offset:34816
    v_mfma_f32_16x16x32_bf16 v[240:243], a[8:11], v[120:123], v[240:243]
    s_waitcnt lgkmcnt(12)
    ds_read_b64_tr_b16 a[146:147], v3 offset:4096
    v_mfma_f32_16x16x32_bf16 v[240:243], a[16:19], v[124:127], v[240:243]
    buffer_load_dwordx4 v7, s[12:15], s54 offen lds
    v_mfma_f32_16x16x32_bf16 v[244:247], a[20:23], v[124:127], v[244:247]
    s_add_u32 m0, s60, 65536
    s_xor_b32 s55, s59, 1540096
    ds_read_b64_tr_b16 a[148:149], v4 offset:0
    v_mfma_f32_16x16x32_bf16 v[244:247], a[12:15], v[120:123], v[244:247]
    ds_read_b64_tr_b16 a[150:151], v4 offset:4096
    v_mfma_f32_16x16x32_bf16 v[244:247], a[4:7], v[116:119], v[244:247]
    v_mfma_f32_16x16x32_bf16 v[252:255], a[4:7], v[120:123], v[252:255]
    v_mfma_f32_16x16x32_bf16 v[252:255], a[12:15], v[124:127], v[252:255]
    buffer_load_dwordx4 v7, s[12:15], s55 offen lds
    v_mfma_f32_16x16x32_bf16 v[248:251], a[8:11], v[124:127], v[248:251]
    s_add_u32 m0, s60, 69632
    s_xor_b32 s52, s59, 1544192
    v_mfma_f32_16x16x32_bf16 v[248:251], a[0:3], v[120:123], v[248:251]
    s_waitcnt lgkmcnt(8)
    ds_read_b128 v[108:111], v2 offset:35840
    v_mfma_f32_16x16x32_bf16 v[128:131], a[32:35], v[96:99], v[128:131]
    s_waitcnt lgkmcnt(8)
    v_mfma_f32_16x16x32_bf16 v[128:131], a[40:43], v[100:103], v[128:131]
    v_mfma_f32_16x16x32_bf16 v[132:135], a[44:47], v[100:103], v[132:135]
    ds_read_b128 v[112:115], v2 offset:36864
    v_mfma_f32_16x16x32_bf16 v[132:135], a[36:39], v[96:99], v[132:135]
    buffer_load_dwordx4 v7, s[12:15], s52 offen lds
    v_mfma_f32_16x16x32_bf16 v[140:143], a[28:31], v[96:99], v[140:143]
    s_add_u32 m0, s61, 16384
    s_xor_b32 s53, s58, 8704
    v_mfma_f32_16x16x32_bf16 v[140:143], a[36:39], v[100:103], v[140:143]
    s_waitcnt lgkmcnt(5)
    v_mfma_f32_16x16x32_bf16 v[140:143], a[44:47], v[104:107], v[140:143]
    v_mfma_f32_16x16x32_bf16 v[136:139], a[40:43], v[104:107], v[136:139]
    v_mfma_f32_16x16x32_bf16 v[136:139], a[32:35], v[100:103], v[136:139]
    ds_read_b128 v[116:119], v2 offset:37888
    v_mfma_f32_16x16x32_bf16 v[136:139], a[24:27], v[96:99], v[136:139]
    buffer_load_dwordx4 v8, s[8:11], s53 offen offset:0 nt lds
    v_mfma_f32_16x16x32_bf16 v[144:147], a[24:27], v[100:103], v[144:147]
    v_mfma_f32_16x16x32_bf16 v[144:147], a[32:35], v[104:107], v[144:147]
    s_waitcnt lgkmcnt(2)
    v_mfma_f32_16x16x32_bf16 v[144:147], a[40:43], v[108:111], v[144:147]
    v_mfma_f32_16x16x32_bf16 v[148:151], a[44:47], v[108:111], v[148:151]
    v_mfma_f32_16x16x32_bf16 v[148:151], a[36:39], v[104:107], v[148:151]
    buffer_load_dwordx4 v8, s[8:11], s53 offen offset:2048 nt lds
    v_mfma_f32_16x16x32_bf16 v[148:151], a[28:31], v[100:103], v[148:151]
    s_add_u32 m0, s61, 20480
    s_xor_b32 s54, s58, 12800
    ds_read_b128 v[120:123], v2 offset:38912
    v_mfma_f32_16x16x32_bf16 v[156:159], a[28:31], v[104:107], v[156:159]
    v_mfma_f32_16x16x32_bf16 v[156:159], a[36:39], v[108:111], v[156:159]
    s_waitcnt lgkmcnt(2)
    v_mfma_f32_16x16x32_bf16 v[156:159], a[44:47], v[112:115], v[156:159]
    v_mfma_f32_16x16x32_bf16 v[152:155], a[40:43], v[112:115], v[152:155]
    v_mfma_f32_16x16x32_bf16 v[152:155], a[32:35], v[108:111], v[152:155]
    buffer_load_dwordx4 v8, s[8:11], s54 offen offset:0 nt lds
    v_mfma_f32_16x16x32_bf16 v[152:155], a[24:27], v[104:107], v[152:155]
    ds_read_b128 v[124:127], v2 offset:39936
    v_mfma_f32_16x16x32_bf16 v[160:163], a[24:27], v[108:111], v[160:163]
    v_mfma_f32_16x16x32_bf16 v[160:163], a[32:35], v[112:115], v[160:163]
    s_waitcnt lgkmcnt(2)
    v_mfma_f32_16x16x32_bf16 v[160:163], a[40:43], v[116:119], v[160:163]
    v_mfma_f32_16x16x32_bf16 v[164:167], a[44:47], v[116:119], v[164:167]
    v_mfma_f32_16x16x32_bf16 v[164:167], a[36:39], v[112:115], v[164:167]
    buffer_load_dwordx4 v8, s[8:11], s54 offen offset:2048 nt lds
    v_mfma_f32_16x16x32_bf16 v[164:167], a[28:31], v[108:111], v[164:167]
    s_add_u32 m0, s60, 73728
    s_xor_b32 s55, s59, 294912
    ds_read_b128 v[96:99], v2 offset:49152
    v_mfma_f32_16x16x32_bf16 v[172:175], a[28:31], v[112:115], v[172:175]
    v_mfma_f32_16x16x32_bf16 v[172:175], a[36:39], v[116:119], v[172:175]
    s_waitcnt lgkmcnt(2)
    v_mfma_f32_16x16x32_bf16 v[172:175], a[44:47], v[120:123], v[172:175]
    v_mfma_f32_16x16x32_bf16 v[168:171], a[40:43], v[120:123], v[168:171]
    v_mfma_f32_16x16x32_bf16 v[168:171], a[32:35], v[116:119], v[168:171]
    s_waitcnt vmcnt(10) lgkmcnt(1)
    ds_read_b128 v[100:103], v2 offset:50176
    v_mfma_f32_16x16x32_bf16 v[168:171], a[24:27], v[112:115], v[168:171]
    s_barrier
    ds_read_b64_tr_b16 a[8:9], v3 offset:32768
    v_mfma_f32_16x16x32_bf16 v[176:179], a[24:27], v[116:119], v[176:179]
    buffer_load_dwordx4 v7, s[12:15], s55 offen lds
    v_mfma_f32_16x16x32_bf16 v[176:179], a[32:35], v[120:123], v[176:179]
    s_add_u32 m0, s60, 77824
    s_xor_b32 s52, s59, 299008
    ds_read_b64_tr_b16 a[10:11], v3 offset:36864
    v_mfma_f32_16x16x32_bf16 v[176:179], a[40:43], v[124:127], v[176:179]
    ds_read_b64_tr_b16 a[12:13], v4 offset:32768
    v_mfma_f32_16x16x32_bf16 v[180:183], a[44:47], v[124:127], v[180:183]
    ds_read_b64_tr_b16 a[14:15], v4 offset:36864
    v_mfma_f32_16x16x32_bf16 v[180:183], a[36:39], v[120:123], v[180:183]
    ds_read_b128 v[104:107], v2 offset:51200
    v_mfma_f32_16x16x32_bf16 v[180:183], a[28:31], v[116:119], v[180:183]
    ds_read_b64_tr_b16 a[16:17], v3 offset:40960
    v_mfma_f32_16x16x32_bf16 v[188:191], a[28:31], v[120:123], v[188:191]
    buffer_load_dwordx4 v7, s[12:15], s52 offen lds
    v_mfma_f32_16x16x32_bf16 v[188:191], a[36:39], v[124:127], v[188:191]
    s_waitcnt lgkmcnt(7)
    s_add_u32 m0, s60, 81920
    ds_read_b64_tr_b16 a[18:19], v3 offset:45056
    v_mfma_f32_16x16x32_bf16 v[188:191], a[44:47], v[96:99], v[188:191]
    s_xor_b32 s53, s59, 819200
    ds_read_b64_tr_b16 a[20:21], v4 offset:40960
    v_mfma_f32_16x16x32_bf16 v[184:187], a[40:43], v[96:99], v[184:187]
    ds_read_b64_tr_b16 a[22:23], v4 offset:45056
    v_mfma_f32_16x16x32_bf16 v[184:187], a[32:35], v[124:127], v[184:187]
    ds_read_b128 v[108:111], v2 offset:52224
    v_mfma_f32_16x16x32_bf16 v[184:187], a[24:27], v[120:123], v[184:187]
    ds_read_b64_tr_b16 a[0:1], v3 offset:24576
    v_mfma_f32_16x16x32_bf16 v[192:195], a[24:27], v[124:127], v[192:195]
    ds_read_b64_tr_b16 a[2:3], v3 offset:28672
    v_mfma_f32_16x16x32_bf16 v[192:195], a[32:35], v[96:99], v[192:195]
    s_waitcnt lgkmcnt(12)
    ds_read_b64_tr_b16 a[4:5], v4 offset:24576
    v_mfma_f32_16x16x32_bf16 v[192:195], a[40:43], v[100:103], v[192:195]
    buffer_load_dwordx4 v7, s[12:15], s53 offen lds
    v_mfma_f32_16x16x32_bf16 v[196:199], a[44:47], v[100:103], v[196:199]
    s_add_u32 m0, s60, 86016
    s_xor_b32 s54, s59, 823296
    ds_read_b64_tr_b16 a[6:7], v4 offset:28672
    v_mfma_f32_16x16x32_bf16 v[196:199], a[36:39], v[96:99], v[196:199]
    ds_read_b128 v[112:115], v2 offset:53248
    v_mfma_f32_16x16x32_bf16 v[196:199], a[28:31], v[124:127], v[196:199]
    v_mfma_f32_16x16x32_bf16 v[204:207], a[28:31], v[96:99], v[204:207]
    v_mfma_f32_16x16x32_bf16 v[204:207], a[36:39], v[100:103], v[204:207]
    s_waitcnt lgkmcnt(10)
    v_mfma_f32_16x16x32_bf16 v[204:207], a[44:47], v[104:107], v[204:207]
    buffer_load_dwordx4 v7, s[12:15], s54 offen lds
    v_mfma_f32_16x16x32_bf16 v[200:203], a[40:43], v[104:107], v[200:203]
    s_add_u32 m0, s60, 90112
    s_xor_b32 s55, s59, 1343488
    v_mfma_f32_16x16x32_bf16 v[200:203], a[32:35], v[100:103], v[200:203]
    ds_read_b128 v[116:119], v2 offset:54272
    v_mfma_f32_16x16x32_bf16 v[200:203], a[24:27], v[96:99], v[200:203]
    v_mfma_f32_16x16x32_bf16 v[208:211], a[24:27], v[100:103], v[208:211]
    v_mfma_f32_16x16x32_bf16 v[208:211], a[32:35], v[104:107], v[208:211]
    s_waitcnt lgkmcnt(6)
    v_mfma_f32_16x16x32_bf16 v[208:211], a[40:43], v[108:111], v[208:211]
    v_mfma_f32_16x16x32_bf16 v[212:215], a[44:47], v[108:111], v[212:215]
    buffer_load_dwordx4 v7, s[12:15], s55 offen lds
    v_mfma_f32_16x16x32_bf16 v[212:215], a[36:39], v[104:107], v[212:215]
    s_add_u32 m0, s60, 94208
    s_xor_b32 s52, s59, 1347584
    ds_read_b128 v[120:123], v2 offset:55296
    v_mfma_f32_16x16x32_bf16 v[212:215], a[28:31], v[100:103], v[212:215]
    v_mfma_f32_16x16x32_bf16 v[220:223], a[28:31], v[104:107], v[220:223]
    v_mfma_f32_16x16x32_bf16 v[220:223], a[36:39], v[108:111], v[220:223]
    s_waitcnt lgkmcnt(2)
    v_mfma_f32_16x16x32_bf16 v[220:223], a[44:47], v[112:115], v[220:223]
    v_mfma_f32_16x16x32_bf16 v[216:219], a[40:43], v[112:115], v[216:219]
    v_mfma_f32_16x16x32_bf16 v[216:219], a[32:35], v[108:111], v[216:219]
    s_waitcnt vmcnt(9)
    ds_read_b128 v[124:127], v2 offset:56320
    v_mfma_f32_16x16x32_bf16 v[216:219], a[24:27], v[104:107], v[216:219]
    s_barrier
    ds_read_b64_tr_b16 a[176:177], v5 offset:8192
    v_mfma_f32_16x16x32_bf16 v[224:227], a[24:27], v[108:111], v[224:227]
    buffer_load_dwordx4 v7, s[12:15], s52 offen lds
    v_mfma_f32_16x16x32_bf16 v[224:227], a[32:35], v[112:115], v[224:227]
    s_waitcnt lgkmcnt(3)
    s_add_u32 m0, s61, 32768
    ds_read_b64_tr_b16 a[178:179], v5 offset:12288
    v_mfma_f32_16x16x32_bf16 v[224:227], a[40:43], v[116:119], v[224:227]
    s_xor_b32 s53, s58, 640
    ds_read_b64_tr_b16 a[180:181], v6 offset:8192
    v_mfma_f32_16x16x32_bf16 v[228:231], a[44:47], v[116:119], v[228:231]
    ds_read_b64_tr_b16 a[182:183], v6 offset:12288
    v_mfma_f32_16x16x32_bf16 v[228:231], a[36:39], v[112:115], v[228:231]
    ds_read_b64_tr_b16 a[184:185], v5 offset:16384
    v_mfma_f32_16x16x32_bf16 v[228:231], a[28:31], v[108:111], v[228:231]
    ds_read_b64_tr_b16 a[186:187], v5 offset:20480
    v_mfma_f32_16x16x32_bf16 v[236:239], a[28:31], v[112:115], v[236:239]
    ds_read_b128 v[96:99], v1 offset:0
    v_mfma_f32_16x16x32_bf16 v[236:239], a[36:39], v[116:119], v[236:239]
    s_waitcnt lgkmcnt(8)
    ds_read_b128 v[100:103], v1 offset:1024
    v_mfma_f32_16x16x32_bf16 v[236:239], a[44:47], v[120:123], v[236:239]
    buffer_load_dwordx4 v8, s[8:11], s53 offen nt lds
    v_mfma_f32_16x16x32_bf16 v[232:235], a[40:43], v[120:123], v[232:235]
    s_add_u32 m0, s61, 34816
    s_xor_b32 s54, s58, 768
    ds_read_b64_tr_b16 a[188:189], v6 offset:16384
    v_mfma_f32_16x16x32_bf16 v[232:235], a[32:35], v[116:119], v[232:235]
    ds_read_b64_tr_b16 a[190:191], v6 offset:20480
    v_mfma_f32_16x16x32_bf16 v[232:235], a[24:27], v[112:115], v[232:235]
    ds_read_b64_tr_b16 a[168:169], v5 offset:0
    v_mfma_f32_16x16x32_bf16 v[240:243], a[24:27], v[116:119], v[240:243]
    ds_read_b128 v[104:107], v1 offset:2048
    v_mfma_f32_16x16x32_bf16 v[240:243], a[32:35], v[120:123], v[240:243]
    s_waitcnt lgkmcnt(12)
    ds_read_b64_tr_b16 a[170:171], v5 offset:4096
    v_mfma_f32_16x16x32_bf16 v[240:243], a[40:43], v[124:127], v[240:243]
    buffer_load_dwordx4 v8, s[8:11], s54 offen nt lds
    v_mfma_f32_16x16x32_bf16 v[244:247], a[44:47], v[124:127], v[244:247]
    s_add_u32 m0, s61, 36864
    s_xor_b32 s55, s58, 896
    ds_read_b64_tr_b16 a[172:173], v6 offset:0
    v_mfma_f32_16x16x32_bf16 v[244:247], a[36:39], v[120:123], v[244:247]
    ds_read_b64_tr_b16 a[174:175], v6 offset:4096
    v_mfma_f32_16x16x32_bf16 v[244:247], a[28:31], v[116:119], v[244:247]
    v_mfma_f32_16x16x32_bf16 v[252:255], a[28:31], v[120:123], v[252:255]
    v_mfma_f32_16x16x32_bf16 v[252:255], a[36:39], v[124:127], v[252:255]
    v_mfma_f32_16x16x32_bf16 v[248:251], a[32:35], v[124:127], v[248:251]
    v_mfma_f32_16x16x32_bf16 v[248:251], a[24:27], v[120:123], v[248:251]
    s_waitcnt lgkmcnt(8)
    ds_read_b128 v[108:111], v1 offset:3072
    v_mfma_f32_16x16x32_bf16 v[128:131], a[8:11], v[96:99], v[128:131]
    s_waitcnt lgkmcnt(8)
    v_mfma_f32_16x16x32_bf16 v[128:131], a[16:19], v[100:103], v[128:131]
    buffer_load_dwordx4 v8, s[8:11], s55 offen nt lds
    v_mfma_f32_16x16x32_bf16 v[132:135], a[20:23], v[100:103], v[132:135]
    s_add_u32 m0, s32, 65536
    s_xor_b32 s52, s58, 4736
    ds_read_b128 v[112:115], v1 offset:4096
    v_mfma_f32_16x16x32_bf16 v[132:135], a[12:15], v[96:99], v[132:135]
    v_mfma_f32_16x16x32_bf16 v[140:143], a[4:7], v[96:99], v[140:143]
    v_mfma_f32_16x16x32_bf16 v[140:143], a[12:15], v[100:103], v[140:143]
    s_waitcnt lgkmcnt(5)
    v_mfma_f32_16x16x32_bf16 v[140:143], a[20:23], v[104:107], v[140:143]
    v_mfma_f32_16x16x32_bf16 v[136:139], a[16:19], v[104:107], v[136:139]
    v_mfma_f32_16x16x32_bf16 v[136:139], a[8:11], v[100:103], v[136:139]
    buffer_load_dwordx4 v8, s[8:11], s52 offen nt lds
    v_mfma_f32_16x16x32_bf16 v[136:139], a[0:3], v[96:99], v[136:139]
    s_add_u32 m0, s32, 67584
    s_xor_b32 s53, s58, 4864
    ds_read_b128 v[116:119], v1 offset:5120
    v_mfma_f32_16x16x32_bf16 v[144:147], a[0:3], v[100:103], v[144:147]
    v_mfma_f32_16x16x32_bf16 v[144:147], a[8:11], v[104:107], v[144:147]
    s_waitcnt lgkmcnt(2)
    v_mfma_f32_16x16x32_bf16 v[144:147], a[16:19], v[108:111], v[144:147]
    v_mfma_f32_16x16x32_bf16 v[148:151], a[20:23], v[108:111], v[148:151]
    v_mfma_f32_16x16x32_bf16 v[148:151], a[12:15], v[104:107], v[148:151]
    ds_read_b128 v[120:123], v1 offset:6144
    v_mfma_f32_16x16x32_bf16 v[148:151], a[4:7], v[100:103], v[148:151]
    buffer_load_dwordx4 v8, s[8:11], s53 offen nt lds
    v_mfma_f32_16x16x32_bf16 v[156:159], a[4:7], v[104:107], v[156:159]
    s_add_u32 m0, s32, 69632
    s_xor_b32 s54, s58, 4992
    v_mfma_f32_16x16x32_bf16 v[156:159], a[12:15], v[108:111], v[156:159]
    s_waitcnt lgkmcnt(2)
    v_mfma_f32_16x16x32_bf16 v[156:159], a[20:23], v[112:115], v[156:159]
    v_mfma_f32_16x16x32_bf16 v[152:155], a[16:19], v[112:115], v[152:155]
    v_mfma_f32_16x16x32_bf16 v[152:155], a[8:11], v[108:111], v[152:155]
    ds_read_b128 v[124:127], v1 offset:7168
    v_mfma_f32_16x16x32_bf16 v[152:155], a[0:3], v[104:107], v[152:155]
    v_mfma_f32_16x16x32_bf16 v[160:163], a[0:3], v[108:111], v[160:163]
    buffer_load_dwordx4 v8, s[8:11], s54 offen nt lds
    v_mfma_f32_16x16x32_bf16 v[160:163], a[8:11], v[112:115], v[160:163]
    s_waitcnt lgkmcnt(2)
    s_add_u32 m0, s32, 77824
    s_xor_b32 s55, s58, 6784
    v_mfma_f32_16x16x32_bf16 v[160:163], a[16:19], v[116:119], v[160:163]
    v_mfma_f32_16x16x32_bf16 v[164:167], a[20:23], v[116:119], v[164:167]
    v_mfma_f32_16x16x32_bf16 v[164:167], a[12:15], v[112:115], v[164:167]
    v_mfma_f32_16x16x32_bf16 v[164:167], a[4:7], v[108:111], v[164:167]
    v_mfma_f32_16x16x32_bf16 v[172:175], a[4:7], v[112:115], v[172:175]
    v_mfma_f32_16x16x32_bf16 v[172:175], a[12:15], v[116:119], v[172:175]
    s_waitcnt lgkmcnt(1)
    v_mfma_f32_16x16x32_bf16 v[172:175], a[20:23], v[120:123], v[172:175]
    buffer_load_dwordx4 v8, s[8:11], s55 offen nt lds
    v_mfma_f32_16x16x32_bf16 v[168:171], a[16:19], v[120:123], v[168:171]
    s_add_u32 m0, s32, 79872
    s_xor_b32 s52, s58, 6912
    v_mfma_f32_16x16x32_bf16 v[168:171], a[8:11], v[116:119], v[168:171]
    s_waitcnt vmcnt(7)
    v_mfma_f32_16x16x32_bf16 v[168:171], a[0:3], v[112:115], v[168:171]
    s_barrier
    ds_read_b128 v[96:99], v1 offset:16384
    v_mfma_f32_16x16x32_bf16 v[176:179], a[0:3], v[116:119], v[176:179]
    ds_read_b128 v[100:103], v1 offset:17408
    v_mfma_f32_16x16x32_bf16 v[176:179], a[8:11], v[120:123], v[176:179]
    s_waitcnt lgkmcnt(2)
    ds_read_b64_tr_b16 a[32:33], v5 offset:32768
    v_mfma_f32_16x16x32_bf16 v[176:179], a[16:19], v[124:127], v[176:179]
    buffer_load_dwordx4 v8, s[8:11], s52 offen nt lds
    v_mfma_f32_16x16x32_bf16 v[180:183], a[20:23], v[124:127], v[180:183]
    s_add_u32 m0, s32, 81920
    s_xor_b32 s53, s58, 7040
    ds_read_b64_tr_b16 a[34:35], v5 offset:36864
    v_mfma_f32_16x16x32_bf16 v[180:183], a[12:15], v[120:123], v[180:183]
    ds_read_b128 v[104:107], v1 offset:18432
    v_mfma_f32_16x16x32_bf16 v[180:183], a[4:7], v[116:119], v[180:183]
    ds_read_b64_tr_b16 a[40:41], v5 offset:40960
    v_mfma_f32_16x16x32_bf16 v[188:191], a[4:7], v[120:123], v[188:191]
    ds_read_b64_tr_b16 a[42:43], v5 offset:45056
    v_mfma_f32_16x16x32_bf16 v[188:191], a[12:15], v[124:127], v[188:191]
    s_waitcnt lgkmcnt(6)
    ds_read_b64_tr_b16 a[44:45], v6 offset:40960
    v_mfma_f32_16x16x32_bf16 v[188:191], a[20:23], v[96:99], v[188:191]
    ds_read_b64_tr_b16 a[46:47], v6 offset:45056
    v_mfma_f32_16x16x32_bf16 v[184:187], a[16:19], v[96:99], v[184:187]
    buffer_load_dwordx4 v8, s[8:11], s53 offen nt lds
    v_mfma_f32_16x16x32_bf16 v[184:187], a[8:11], v[124:127], v[184:187]
    s_add_u32 m0, s32, 90112
    s_xor_b32 s54, s58, 8832
    ds_read_b128 v[108:111], v1 offset:19456
    v_mfma_f32_16x16x32_bf16 v[184:187], a[0:3], v[120:123], v[184:187]
    ds_read_b64_tr_b16 a[36:37], v6 offset:32768
    v_mfma_f32_16x16x32_bf16 v[192:195], a[0:3], v[124:127], v[192:195]
    ds_read_b64_tr_b16 a[38:39], v6 offset:36864
    v_mfma_f32_16x16x32_bf16 v[192:195], a[8:11], v[96:99], v[192:195]
    s_waitcnt lgkmcnt(10)
    ds_read_b64_tr_b16 a[28:29], v6 offset:24576
    v_mfma_f32_16x16x32_bf16 v[192:195], a[16:19], v[100:103], v[192:195]
    ds_read_b64_tr_b16 a[30:31], v6 offset:28672
    v_mfma_f32_16x16x32_bf16 v[196:199], a[20:23], v[100:103], v[196:199]
    ds_read_b64_tr_b16 a[24:25], v5 offset:24576
    v_mfma_f32_16x16x32_bf16 v[196:199], a[12:15], v[96:99], v[196:199]
    buffer_load_dwordx4 v8, s[8:11], s54 offen nt lds
    v_mfma_f32_16x16x32_bf16 v[196:199], a[4:7], v[124:127], v[196:199]
    s_add_u32 m0, s32, 92160
    s_xor_b32 s55, s58, 8960
    ds_read_b128 v[112:115], v1 offset:20480
    v_mfma_f32_16x16x32_bf16 v[204:207], a[4:7], v[96:99], v[204:207]
    ds_read_b64_tr_b16 a[26:27], v5 offset:28672
    v_mfma_f32_16x16x32_bf16 v[204:207], a[12:15], v[100:103], v[204:207]
    s_waitcnt lgkmcnt(12)
    v_mfma_f32_16x16x32_bf16 v[204:207], a[20:23], v[104:107], v[204:207]
    v_mfma_f32_16x16x32_bf16 v[200:203], a[16:19], v[104:107], v[200:203]
    v_mfma_f32_16x16x32_bf16 v[200:203], a[8:11], v[100:103], v[200:203]
    ds_read_b128 v[116:119], v1 offset:21504
    v_mfma_f32_16x16x32_bf16 v[200:203], a[0:3], v[96:99], v[200:203]
    buffer_load_dwordx4 v8, s[8:11], s55 offen nt lds
    v_mfma_f32_16x16x32_bf16 v[208:211], a[0:3], v[100:103], v[208:211]
    s_add_u32 m0, s32, 94208
    s_xor_b32 s52, s58, 9088
    v_mfma_f32_16x16x32_bf16 v[208:211], a[8:11], v[104:107], v[208:211]
    s_waitcnt lgkmcnt(8)
    v_mfma_f32_16x16x32_bf16 v[208:211], a[16:19], v[108:111], v[208:211]
    v_mfma_f32_16x16x32_bf16 v[212:215], a[20:23], v[108:111], v[212:215]
    v_mfma_f32_16x16x32_bf16 v[212:215], a[12:15], v[104:107], v[212:215]
    ds_read_b128 v[120:123], v1 offset:22528
    v_mfma_f32_16x16x32_bf16 v[212:215], a[4:7], v[100:103], v[212:215]
    v_mfma_f32_16x16x32_bf16 v[220:223], a[4:7], v[104:107], v[220:223]
    buffer_load_dwordx4 v8, s[8:11], s52 offen nt lds
    v_mfma_f32_16x16x32_bf16 v[220:223], a[12:15], v[108:111], v[220:223]
    s_waitcnt lgkmcnt(3)
    s_add_u32 m0, s32, 102400
    s_xor_b32 s53, s58, 10880
    v_mfma_f32_16x16x32_bf16 v[220:223], a[20:23], v[112:115], v[220:223]
    v_mfma_f32_16x16x32_bf16 v[216:219], a[16:19], v[112:115], v[216:219]
    v_mfma_f32_16x16x32_bf16 v[216:219], a[8:11], v[108:111], v[216:219]
    ds_read_b128 v[124:127], v1 offset:23552
    v_mfma_f32_16x16x32_bf16 v[216:219], a[0:3], v[104:107], v[216:219]
    v_mfma_f32_16x16x32_bf16 v[224:227], a[0:3], v[108:111], v[224:227]
    v_mfma_f32_16x16x32_bf16 v[224:227], a[8:11], v[112:115], v[224:227]
    s_waitcnt lgkmcnt(2)
    v_mfma_f32_16x16x32_bf16 v[224:227], a[16:19], v[116:119], v[224:227]
    buffer_load_dwordx4 v8, s[8:11], s53 offen nt lds
    v_mfma_f32_16x16x32_bf16 v[228:231], a[20:23], v[116:119], v[228:231]
    s_add_u32 m0, s32, 104448
    s_xor_b32 s54, s58, 11008
    v_mfma_f32_16x16x32_bf16 v[228:231], a[12:15], v[112:115], v[228:231]
    v_mfma_f32_16x16x32_bf16 v[228:231], a[4:7], v[108:111], v[228:231]
    v_mfma_f32_16x16x32_bf16 v[236:239], a[4:7], v[112:115], v[236:239]
    ds_read_b128 v[96:99], v2 offset:0
    v_mfma_f32_16x16x32_bf16 v[236:239], a[12:15], v[116:119], v[236:239]
    s_waitcnt lgkmcnt(2)
    ds_read_b128 v[100:103], v2 offset:1024
    v_mfma_f32_16x16x32_bf16 v[236:239], a[20:23], v[120:123], v[236:239]
    buffer_load_dwordx4 v8, s[8:11], s54 offen nt lds
    v_mfma_f32_16x16x32_bf16 v[232:235], a[16:19], v[120:123], v[232:235]
    s_add_u32 m0, s32, 106496
    s_xor_b32 s55, s58, 11136
    v_mfma_f32_16x16x32_bf16 v[232:235], a[8:11], v[116:119], v[232:235]
    v_mfma_f32_16x16x32_bf16 v[232:235], a[0:3], v[112:115], v[232:235]
    v_mfma_f32_16x16x32_bf16 v[240:243], a[0:3], v[116:119], v[240:243]
    ds_read_b128 v[104:107], v2 offset:2048
    v_mfma_f32_16x16x32_bf16 v[240:243], a[8:11], v[120:123], v[240:243]
    s_waitcnt lgkmcnt(3)
    v_mfma_f32_16x16x32_bf16 v[240:243], a[16:19], v[124:127], v[240:243]
    v_mfma_f32_16x16x32_bf16 v[244:247], a[20:23], v[124:127], v[244:247]
    buffer_load_dwordx4 v8, s[8:11], s55 offen nt lds
    v_mfma_f32_16x16x32_bf16 v[244:247], a[12:15], v[120:123], v[244:247]
    s_add_u32 m0, s61, 49152
    s_xor_b32 s52, s58, 2688
    v_mfma_f32_16x16x32_bf16 v[244:247], a[4:7], v[116:119], v[244:247]
    v_mfma_f32_16x16x32_bf16 v[252:255], a[4:7], v[120:123], v[252:255]
    ds_read_b128 v[108:111], v2 offset:3072
    v_mfma_f32_16x16x32_bf16 v[252:255], a[12:15], v[124:127], v[252:255]
    v_mfma_f32_16x16x32_bf16 v[248:251], a[8:11], v[124:127], v[248:251]
    v_mfma_f32_16x16x32_bf16 v[248:251], a[0:3], v[120:123], v[248:251]
    s_waitcnt lgkmcnt(3)
    v_mfma_f32_16x16x32_bf16 v[128:131], a[32:35], v[96:99], v[128:131]
    s_waitcnt lgkmcnt(2)
    v_mfma_f32_16x16x32_bf16 v[128:131], a[40:43], v[100:103], v[128:131]
    buffer_load_dwordx4 v8, s[8:11], s52 offen nt lds
    v_mfma_f32_16x16x32_bf16 v[132:135], a[44:47], v[100:103], v[132:135]
    s_add_u32 m0, s61, 51200
    s_xor_b32 s53, s58, 2816
    ds_read_b128 v[112:115], v2 offset:4096
    v_mfma_f32_16x16x32_bf16 v[132:135], a[36:39], v[96:99], v[132:135]
    v_mfma_f32_16x16x32_bf16 v[140:143], a[28:31], v[96:99], v[140:143]
    v_mfma_f32_16x16x32_bf16 v[140:143], a[36:39], v[100:103], v[140:143]
    s_waitcnt lgkmcnt(2)
    v_mfma_f32_16x16x32_bf16 v[140:143], a[44:47], v[104:107], v[140:143]
    v_mfma_f32_16x16x32_bf16 v[136:139], a[40:43], v[104:107], v[136:139]
    buffer_load_dwordx4 v8, s[8:11], s53 offen nt lds
    v_mfma_f32_16x16x32_bf16 v[136:139], a[32:35], v[100:103], v[136:139]
    s_add_u32 m0, s61, 53248
    s_xor_b32 s54, s58, 2944
    ds_read_b128 v[116:119], v2 offset:5120
    v_mfma_f32_16x16x32_bf16 v[136:139], a[24:27], v[96:99], v[136:139]
    v_mfma_f32_16x16x32_bf16 v[144:147], a[24:27], v[100:103], v[144:147]
    v_mfma_f32_16x16x32_bf16 v[144:147], a[32:35], v[104:107], v[144:147]
    s_waitcnt lgkmcnt(2)
    v_mfma_f32_16x16x32_bf16 v[144:147], a[40:43], v[108:111], v[144:147]
    v_mfma_f32_16x16x32_bf16 v[148:151], a[44:47], v[108:111], v[148:151]
    v_mfma_f32_16x16x32_bf16 v[148:151], a[36:39], v[104:107], v[148:151]
    buffer_load_dwordx4 v8, s[8:11], s54 offen nt lds
    v_mfma_f32_16x16x32_bf16 v[148:151], a[28:31], v[100:103], v[148:151]
    s_add_u32 m0, s32, 114688
    s_xor_b32 s55, s58, 12928
    ds_read_b128 v[120:123], v2 offset:6144
    v_mfma_f32_16x16x32_bf16 v[156:159], a[28:31], v[104:107], v[156:159]
    v_mfma_f32_16x16x32_bf16 v[156:159], a[36:39], v[108:111], v[156:159]
    s_waitcnt lgkmcnt(2)
    v_mfma_f32_16x16x32_bf16 v[156:159], a[44:47], v[112:115], v[156:159]
    v_mfma_f32_16x16x32_bf16 v[152:155], a[40:43], v[112:115], v[152:155]
    v_mfma_f32_16x16x32_bf16 v[152:155], a[32:35], v[108:111], v[152:155]
    ds_read_b128 v[124:127], v2 offset:7168
    v_mfma_f32_16x16x32_bf16 v[152:155], a[24:27], v[104:107], v[152:155]
    buffer_load_dwordx4 v8, s[8:11], s55 offen nt lds
    v_mfma_f32_16x16x32_bf16 v[160:163], a[24:27], v[108:111], v[160:163]
    s_add_u32 m0, s32, 116736
    s_xor_b32 s52, s58, 13056
    v_mfma_f32_16x16x32_bf16 v[160:163], a[32:35], v[112:115], v[160:163]
    s_waitcnt lgkmcnt(2)
    v_mfma_f32_16x16x32_bf16 v[160:163], a[40:43], v[116:119], v[160:163]
    v_mfma_f32_16x16x32_bf16 v[164:167], a[44:47], v[116:119], v[164:167]
    v_mfma_f32_16x16x32_bf16 v[164:167], a[36:39], v[112:115], v[164:167]
    ds_read_b128 v[96:99], v2 offset:16384
    v_mfma_f32_16x16x32_bf16 v[164:167], a[28:31], v[108:111], v[164:167]
    v_mfma_f32_16x16x32_bf16 v[172:175], a[28:31], v[112:115], v[172:175]
    buffer_load_dwordx4 v8, s[8:11], s52 offen nt lds
    v_mfma_f32_16x16x32_bf16 v[172:175], a[36:39], v[116:119], v[172:175]
    s_waitcnt lgkmcnt(2)
    s_add_u32 m0, s32, 118784
    s_xor_b32 s53, s58, 13184
    v_mfma_f32_16x16x32_bf16 v[172:175], a[44:47], v[120:123], v[172:175]
    v_mfma_f32_16x16x32_bf16 v[168:171], a[40:43], v[120:123], v[168:171]
    v_mfma_f32_16x16x32_bf16 v[168:171], a[32:35], v[116:119], v[168:171]
    s_waitcnt vmcnt(17)
    ds_read_b128 v[100:103], v2 offset:17408
    v_mfma_f32_16x16x32_bf16 v[168:171], a[24:27], v[112:115], v[168:171]
    s_barrier
    v_mfma_f32_16x16x32_bf16 v[176:179], a[24:27], v[116:119], v[176:179]
    v_mfma_f32_16x16x32_bf16 v[176:179], a[32:35], v[120:123], v[176:179]
    s_waitcnt lgkmcnt(2)
    v_mfma_f32_16x16x32_bf16 v[176:179], a[40:43], v[124:127], v[176:179]
    buffer_load_dwordx4 v8, s[8:11], s53 offen nt lds
    v_mfma_f32_16x16x32_bf16 v[180:183], a[44:47], v[124:127], v[180:183]
    s_add_u32 m0, s32, 126976
    s_xor_b32 s54, s58, 14976
    v_mfma_f32_16x16x32_bf16 v[180:183], a[36:39], v[120:123], v[180:183]
    ds_read_b128 v[104:107], v2 offset:18432
    v_mfma_f32_16x16x32_bf16 v[180:183], a[28:31], v[116:119], v[180:183]
    v_mfma_f32_16x16x32_bf16 v[188:191], a[28:31], v[120:123], v[188:191]
    v_mfma_f32_16x16x32_bf16 v[188:191], a[36:39], v[124:127], v[188:191]
    s_waitcnt lgkmcnt(2)
    v_mfma_f32_16x16x32_bf16 v[188:191], a[44:47], v[96:99], v[188:191]
    buffer_load_dwordx4 v8, s[8:11], s54 offen nt lds
    v_mfma_f32_16x16x32_bf16 v[184:187], a[40:43], v[96:99], v[184:187]
    s_add_u32 m0, s32, 129024
    s_xor_b32 s55, s58, 15104
    v_mfma_f32_16x16x32_bf16 v[184:187], a[32:35], v[124:127], v[184:187]
    ds_read_b128 v[108:111], v2 offset:19456
    v_mfma_f32_16x16x32_bf16 v[184:187], a[24:27], v[120:123], v[184:187]
    v_mfma_f32_16x16x32_bf16 v[192:195], a[24:27], v[124:127], v[192:195]
    v_mfma_f32_16x16x32_bf16 v[192:195], a[32:35], v[96:99], v[192:195]
    s_waitcnt lgkmcnt(2)
    v_mfma_f32_16x16x32_bf16 v[192:195], a[40:43], v[100:103], v[192:195]
    v_mfma_f32_16x16x32_bf16 v[196:199], a[44:47], v[100:103], v[196:199]
    buffer_load_dwordx4 v8, s[8:11], s55 offen nt lds
    v_mfma_f32_16x16x32_bf16 v[196:199], a[36:39], v[96:99], v[196:199]
    s_add_u32 m0, s32, 131072
    s_xor_b32 s52, s58, 15232
    ds_read_b128 v[112:115], v2 offset:20480
    v_mfma_f32_16x16x32_bf16 v[196:199], a[28:31], v[124:127], v[196:199]
    v_mfma_f32_16x16x32_bf16 v[204:207], a[28:31], v[96:99], v[204:207]
    v_mfma_f32_16x16x32_bf16 v[204:207], a[36:39], v[100:103], v[204:207]
    s_waitcnt lgkmcnt(2)
    v_mfma_f32_16x16x32_bf16 v[204:207], a[44:47], v[104:107], v[204:207]
    v_mfma_f32_16x16x32_bf16 v[200:203], a[40:43], v[104:107], v[200:203]
    v_mfma_f32_16x16x32_bf16 v[200:203], a[32:35], v[100:103], v[200:203]
    buffer_load_dwordx4 v8, s[8:11], s52 offen nt lds
    v_mfma_f32_16x16x32_bf16 v[200:203], a[24:27], v[96:99], v[200:203]
    ds_read_b128 v[116:119], v2 offset:21504
    v_mfma_f32_16x16x32_bf16 v[208:211], a[24:27], v[100:103], v[208:211]
    v_mfma_f32_16x16x32_bf16 v[208:211], a[32:35], v[104:107], v[208:211]
    s_waitcnt lgkmcnt(2)
    v_mfma_f32_16x16x32_bf16 v[208:211], a[40:43], v[108:111], v[208:211]
    v_mfma_f32_16x16x32_bf16 v[212:215], a[44:47], v[108:111], v[212:215]
    v_mfma_f32_16x16x32_bf16 v[212:215], a[36:39], v[104:107], v[212:215]
    ds_read_b128 v[120:123], v2 offset:22528
    v_mfma_f32_16x16x32_bf16 v[212:215], a[28:31], v[100:103], v[212:215]
    ds_read_b128 v[64:67], v1 offset:32768
    v_mfma_f32_16x16x32_bf16 v[220:223], a[28:31], v[104:107], v[220:223]
    ds_read_b128 v[68:71], v2 offset:32768
    v_mfma_f32_16x16x32_bf16 v[220:223], a[36:39], v[108:111], v[220:223]
    s_waitcnt lgkmcnt(4)
    ds_read_b128 v[72:75], v1 offset:34816
    v_mfma_f32_16x16x32_bf16 v[220:223], a[44:47], v[112:115], v[220:223]
    ds_read_b128 v[76:79], v2 offset:34816
    v_mfma_f32_16x16x32_bf16 v[216:219], a[40:43], v[112:115], v[216:219]
    ds_read_b128 v[80:83], v1 offset:36864
    v_mfma_f32_16x16x32_bf16 v[216:219], a[32:35], v[108:111], v[216:219]
    ds_read_b128 v[124:127], v2 offset:23552
    v_mfma_f32_16x16x32_bf16 v[216:219], a[24:27], v[104:107], v[216:219]
    ds_read_b128 v[84:87], v2 offset:36864
L_stub3:
    s_cbranch_vccnz L_back0
    v_mfma_f32_16x16x32_bf16 v[224:227], a[24:27], v[108:111], v[224:227]
    ds_read_b128 a[212:215], v2 offset:37888
    v_mfma_f32_16x16x32_bf16 v[224:227], a[32:35], v[112:115], v[224:227]
    s_waitcnt lgkmcnt(9)
    ds_read_b128 a[208:211], v1 offset:37888
    v_mfma_f32_16x16x32_bf16 v[224:227], a[40:43], v[116:119], v[224:227]
    ds_read_b128 a[204:207], v2 offset:35840
    v_mfma_f32_16x16x32_bf16 v[228:231], a[44:47], v[116:119], v[228:231]
    ds_read_b128 a[200:203], v1 offset:35840
    v_mfma_f32_16x16x32_bf16 v[228:231], a[36:39], v[112:115], v[228:231]
    ds_read_b128 a[196:199], v2 offset:33792
    v_mfma_f32_16x16x32_bf16 v[228:231], a[28:31], v[108:111], v[228:231]
    ds_read_b128 a[192:195], v1 offset:33792
    v_mfma_f32_16x16x32_bf16 v[236:239], a[28:31], v[112:115], v[236:239]
    v_mfma_f32_16x16x32_bf16 v[236:239], a[36:39], v[116:119], v[236:239]
    s_waitcnt lgkmcnt(13)
    v_mfma_f32_16x16x32_bf16 v[236:239], a[44:47], v[120:123], v[236:239]
    v_mfma_f32_16x16x32_bf16 v[232:235], a[40:43], v[120:123], v[232:235]
    v_mfma_f32_16x16x32_bf16 v[232:235], a[32:35], v[116:119], v[232:235]
    v_mfma_f32_16x16x32_bf16 v[232:235], a[24:27], v[112:115], v[232:235]
    v_mfma_f32_16x16x32_bf16 v[240:243], a[24:27], v[116:119], v[240:243]
    v_mfma_f32_16x16x32_bf16 v[240:243], a[32:35], v[120:123], v[240:243]
    s_waitcnt lgkmcnt(7)
    v_mfma_f32_16x16x32_bf16 v[240:243], a[40:43], v[124:127], v[240:243]
    v_mfma_f32_16x16x32_bf16 v[244:247], a[44:47], v[124:127], v[244:247]
    v_mfma_f32_16x16x32_bf16 v[244:247], a[36:39], v[120:123], v[244:247]
    v_mfma_f32_16x16x32_bf16 v[244:247], a[28:31], v[116:119], v[244:247]
    v_mfma_f32_16x16x32_bf16 v[252:255], a[28:31], v[120:123], v[252:255]
    v_mfma_f32_16x16x32_bf16 v[252:255], a[36:39], v[124:127], v[252:255]
    v_mfma_f32_16x16x32_bf16 v[248:251], a[32:35], v[124:127], v[248:251]
    v_mfma_f32_16x16x32_bf16 v[248:251], a[24:27], v[120:123], v[248:251]
    v_mfma_f32_16x16x32_bf16 v[128:131], a[56:59], v[64:67], v[128:131]
    v_mfma_f32_16x16x32_bf16 v[128:131], a[80:83], v[68:71], v[128:131]
    v_mfma_f32_16x16x32_bf16 v[128:131], a[104:107], v[72:75], v[128:131]
    v_mfma_f32_16x16x32_bf16 v[128:131], a[128:131], v[76:79], v[128:131]
    s_waitcnt vmcnt(6)
    v_mfma_f32_16x16x32_bf16 v[128:131], a[152:155], v[80:83], v[128:131]
    s_barrier
    s_waitcnt lgkmcnt(6)
    v_mfma_f32_16x16x32_bf16 v[128:131], a[176:179], v[84:87], v[128:131]
    s_waitcnt lgkmcnt(5)
    v_mfma_f32_16x16x32_bf16 v[128:131], a[184:187], a[212:215], v[128:131]
    s_waitcnt lgkmcnt(4)
    ds_read_b128 v[96:99], v1 offset:49152
    v_mfma_f32_16x16x32_bf16 v[128:131], a[160:163], a[208:211], v[128:131]
    s_waitcnt lgkmcnt(4)
    ds_read_b128 v[100:103], v2 offset:49152
    v_mfma_f32_16x16x32_bf16 v[128:131], a[136:139], a[204:207], v[128:131]
    s_waitcnt lgkmcnt(4)
    ds_read_b128 v[104:107], v1 offset:51200
    v_mfma_f32_16x16x32_bf16 v[128:131], a[112:115], a[200:203], v[128:131]
    s_waitcnt lgkmcnt(4)
    ds_read_b128 v[108:111], v2 offset:51200
    v_mfma_f32_16x16x32_bf16 v[128:131], a[88:91], a[196:199], v[128:131]
    s_waitcnt lgkmcnt(4)
    ds_read_b128 v[112:115], v1 offset:53248
    v_mfma_f32_16x16x32_bf16 v[128:131], a[64:67], a[192:195], v[128:131]
    ds_read_b128 v[116:119], v2 offset:53248
    v_mfma_f32_16x16x32_bf16 v[132:135], a[68:71], a[192:195], v[132:135]
    v_mfma_f32_16x16x32_bf16 v[132:135], a[92:95], a[196:199], v[132:135]
    v_mfma_f32_16x16x32_bf16 v[132:135], a[116:119], a[200:203], v[132:135]
    v_mfma_f32_16x16x32_bf16 v[132:135], a[140:143], a[204:207], v[132:135]
    v_mfma_f32_16x16x32_bf16 v[132:135], a[164:167], a[208:211], v[132:135]
    v_mfma_f32_16x16x32_bf16 v[132:135], a[188:191], a[212:215], v[132:135]
    v_mfma_f32_16x16x32_bf16 v[132:135], a[180:183], v[84:87], v[132:135]
    v_fma_f32 v128, v128, v40, v48
    v_fma_f32 v129, v129, v41, v49
    v_mfma_f32_16x16x32_bf16 v[132:135], a[156:159], v[80:83], v[132:135]
    v_fma_f32 v130, v130, v42, v50
    v_fma_f32 v131, v131, v43, v51
    v_mfma_f32_16x16x32_bf16 v[132:135], a[132:135], v[76:79], v[132:135]
    v_exp_f32 v16, v128
    v_mfma_f32_16x16x32_bf16 v[132:135], a[108:111], v[72:75], v[132:135]
    v_exp_f32 v17, v129
    v_mfma_f32_16x16x32_bf16 v[132:135], a[84:87], v[68:71], v[132:135]
    v_exp_f32 v18, v130
    v_mfma_f32_16x16x32_bf16 v[132:135], a[60:63], v[64:67], v[132:135]
    v_exp_f32 v19, v131
    v_mfma_f32_16x16x32_bf16 v[140:143], a[52:55], v[64:67], v[140:143]
    v_fma_f32 v16, v16, s34, s34
    v_fma_f32 v17, v17, s34, s34
    v_mfma_f32_16x16x32_bf16 v[140:143], a[76:79], v[68:71], v[140:143]
    v_fma_f32 v18, v18, s34, s34
    v_fma_f32 v19, v19, s34, s34
    v_mfma_f32_16x16x32_bf16 v[140:143], a[100:103], v[72:75], v[140:143]
    v_rcp_f32 v16, v16
    v_mfma_f32_16x16x32_bf16 v[140:143], a[124:127], v[76:79], v[140:143]
    v_rcp_f32 v17, v17
    v_mfma_f32_16x16x32_bf16 v[140:143], a[148:151], v[80:83], v[140:143]
    v_rcp_f32 v18, v18
    v_mfma_f32_16x16x32_bf16 v[140:143], a[172:175], v[84:87], v[140:143]
    v_rcp_f32 v19, v19
    v_mfma_f32_16x16x32_bf16 v[140:143], a[180:183], a[212:215], v[140:143]
    v_mul_f32 v128, v128, v16
    v_mul_f32 v129, v129, v17
    v_mfma_f32_16x16x32_bf16 v[140:143], a[156:159], a[208:211], v[140:143]
    v_mul_f32 v130, v130, v18
    v_mul_f32 v131, v131, v19
    v_mfma_f32_16x16x32_bf16 v[140:143], a[132:135], a[204:207], v[140:143]
    v_cvt_pk_bf16_f32 v131, v130, v131
    v_fma_f32 v132, v132, v44, v52
    v_mfma_f32_16x16x32_bf16 v[140:143], a[108:111], a[200:203], v[140:143]
    v_cvt_pk_bf16_f32 v130, v128, v129
    v_fma_f32 v133, v133, v45, v53
    v_mfma_f32_16x16x32_bf16 v[140:143], a[84:87], a[196:199], v[140:143]
    v_fma_f32 v134, v134, v46, v54
    v_fma_f32 v135, v135, v47, v55
    v_mfma_f32_16x16x32_bf16 v[140:143], a[60:63], a[192:195], v[140:143]
    s_waitcnt lgkmcnt(5)
    v_exp_f32 v20, v132
    v_mfma_f32_16x16x32_bf16 v[140:143], a[68:71], v[96:99], v[140:143]
    s_waitcnt lgkmcnt(4)
    v_exp_f32 v21, v133
    v_mfma_f32_16x16x32_bf16 v[140:143], a[92:95], v[100:103], v[140:143]
    s_waitcnt lgkmcnt(3)
    v_exp_f32 v22, v134
    v_mfma_f32_16x16x32_bf16 v[140:143], a[116:119], v[104:107], v[140:143]
    s_waitcnt lgkmcnt(2)
    v_exp_f32 v23, v135
    v_mfma_f32_16x16x32_bf16 v[140:143], a[140:143], v[108:111], v[140:143]
    s_waitcnt lgkmcnt(1)
    v_fma_f32 v20, v20, s34, s34
    v_fma_f32 v21, v21, s34, s34
    v_mfma_f32_16x16x32_bf16 v[140:143], a[164:167], v[112:115], v[140:143]
    s_waitcnt lgkmcnt(0)
    v_fma_f32 v22, v22, s34, s34
    v_fma_f32 v23, v23, s34, s34
    v_mfma_f32_16x16x32_bf16 v[140:143], a[188:191], v[116:119], v[140:143]
    v_rcp_f32 v20, v20
    v_mfma_f32_16x16x32_bf16 v[136:139], a[184:187], v[116:119], v[136:139]
    ds_read_b128 a[216:219], v1 offset:50176
    v_mul_f32 v132, v132, v20
    v_mfma_f32_16x16x32_bf16 v[136:139], a[160:163], v[112:115], v[136:139]
    ds_read_b128 a[220:223], v2 offset:50176
    v_mfma_f32_16x16x32_bf16 v[136:139], a[136:139], v[108:111], v[136:139]
    ds_read_b128 a[224:227], v1 offset:52224
    v_fma_f32 v140, v140, v44, v52
    v_mfma_f32_16x16x32_bf16 v[136:139], a[112:115], v[104:107], v[136:139]
    ds_read_b128 a[228:231], v2 offset:52224
    v_fma_f32 v141, v141, v45, v53
    v_mfma_f32_16x16x32_bf16 v[136:139], a[88:91], v[100:103], v[136:139]
    ds_read_b128 a[232:235], v1 offset:54272
    v_fma_f32 v142, v142, v46, v54
    v_mfma_f32_16x16x32_bf16 v[136:139], a[64:67], v[96:99], v[136:139]
    ds_read_b128 a[236:239], v2 offset:54272
    v_fma_f32 v143, v143, v47, v55
    v_mfma_f32_16x16x32_bf16 v[136:139], a[56:59], a[192:195], v[136:139]
    v_rcp_f32 v21, v21
    v_mfma_f32_16x16x32_bf16 v[136:139], a[80:83], a[196:199], v[136:139]
    v_rcp_f32 v22, v22
    v_mfma_f32_16x16x32_bf16 v[136:139], a[104:107], a[200:203], v[136:139]
    v_rcp_f32 v23, v23
    v_mfma_f32_16x16x32_bf16 v[136:139], a[128:131], a[204:207], v[136:139]
    v_mul_f32 v133, v133, v21
    v_mul_f32 v134, v134, v22
    v_mfma_f32_16x16x32_bf16 v[136:139], a[152:155], a[208:211], v[136:139]
    v_mul_f32 v135, v135, v23
    v_cvt_pk_bf16_f32 v132, v132, v133
    v_mfma_f32_16x16x32_bf16 v[136:139], a[176:179], a[212:215], v[136:139]
    v_cvt_pk_bf16_f32 v133, v134, v135
    v_mfma_f32_16x16x32_bf16 v[136:139], a[168:171], v[84:87], v[136:139]
    v_exp_f32 v28, v140
    v_mfma_f32_16x16x32_bf16 v[136:139], a[144:147], v[80:83], v[136:139]
    v_exp_f32 v29, v141
    v_mfma_f32_16x16x32_bf16 v[136:139], a[120:123], v[76:79], v[136:139]
    v_exp_f32 v30, v142
    v_mfma_f32_16x16x32_bf16 v[136:139], a[96:99], v[72:75], v[136:139]
    v_exp_f32 v31, v143
    v_mfma_f32_16x16x32_bf16 v[136:139], a[72:75], v[68:71], v[136:139]
    v_fma_f32 v28, v28, s34, s34
    v_fma_f32 v29, v29, s34, s34
    v_mfma_f32_16x16x32_bf16 v[136:139], a[48:51], v[64:67], v[136:139]
    v_fma_f32 v30, v30, s34, s34
    v_fma_f32 v31, v31, s34, s34
    v_mfma_f32_16x16x32_bf16 v[144:147], a[48:51], a[192:195], v[144:147]
    v_rcp_f32 v28, v28
    v_mfma_f32_16x16x32_bf16 v[144:147], a[72:75], a[196:199], v[144:147]
    v_rcp_f32 v29, v29
    v_mfma_f32_16x16x32_bf16 v[144:147], a[96:99], a[200:203], v[144:147]
    v_rcp_f32 v30, v30
    v_mfma_f32_16x16x32_bf16 v[144:147], a[120:123], a[204:207], v[144:147]
    v_rcp_f32 v31, v31
    v_mfma_f32_16x16x32_bf16 v[144:147], a[144:147], a[208:211], v[144:147]
    v_mul_f32 v140, v140, v28
    v_mul_f32 v141, v141, v29
    v_mfma_f32_16x16x32_bf16 v[144:147], a[168:171], a[212:215], v[144:147]
    v_mul_f32 v142, v142, v30
    v_mul_f32 v143, v143, v31
    v_mfma_f32_16x16x32_bf16 v[144:147], a[176:179], v[116:119], v[144:147]
    v_cvt_pk_bf16_f32 v140, v140, v141
    v_fma_f32 v136, v136, v40, v48
    v_mfma_f32_16x16x32_bf16 v[144:147], a[152:155], v[112:115], v[144:147]
    v_cvt_pk_bf16_f32 v141, v142, v143
    v_fma_f32 v137, v137, v41, v49
    v_mfma_f32_16x16x32_bf16 v[144:147], a[128:131], v[108:111], v[144:147]
    v_fma_f32 v138, v138, v42, v50
    v_fma_f32 v139, v139, v43, v51
    v_mfma_f32_16x16x32_bf16 v[144:147], a[104:107], v[104:107], v[144:147]
    v_exp_f32 v24, v136
    v_mfma_f32_16x16x32_bf16 v[144:147], a[80:83], v[100:103], v[144:147]
    v_exp_f32 v25, v137
    v_mfma_f32_16x16x32_bf16 v[144:147], a[56:59], v[96:99], v[144:147]
    s_waitcnt lgkmcnt(5)
    v_exp_f32 v26, v138
    v_mfma_f32_16x16x32_bf16 v[144:147], a[64:67], a[216:219], v[144:147]
    s_waitcnt lgkmcnt(4)
    v_exp_f32 v27, v139
    v_mfma_f32_16x16x32_bf16 v[144:147], a[88:91], a[220:223], v[144:147]
    s_waitcnt lgkmcnt(3)
    v_fma_f32 v24, v24, s34, s34
    v_fma_f32 v25, v25, s34, s34
    v_mfma_f32_16x16x32_bf16 v[144:147], a[112:115], a[224:227], v[144:147]
    s_waitcnt lgkmcnt(2)
    v_fma_f32 v26, v26, s34, s34
    v_fma_f32 v27, v27, s34, s34
    v_mfma_f32_16x16x32_bf16 v[144:147], a[136:139], a[228:231], v[144:147]
    s_waitcnt lgkmcnt(1)
    v_rcp_f32 v24, v24
    v_mfma_f32_16x16x32_bf16 v[144:147], a[160:163], a[232:235], v[144:147]
    s_waitcnt lgkmcnt(0)
    v_rcp_f32 v25, v25
    v_mfma_f32_16x16x32_bf16 v[144:147], a[184:187], a[236:239], v[144:147]
    v_rcp_f32 v26, v26
    v_mfma_f32_16x16x32_bf16 v[148:151], a[188:191], a[236:239], v[148:151]
    ds_read_b128 v[64:67], v12 offset:0
    v_mul_f32 v136, v136, v24
    v_mfma_f32_16x16x32_bf16 v[148:151], a[164:167], a[232:235], v[148:151]
    ds_read_b128 v[68:71], v13 offset:0
    v_mul_f32 v137, v137, v25
    v_mfma_f32_16x16x32_bf16 v[148:151], a[140:143], a[228:231], v[148:151]
    ds_read_b128 v[72:75], v12 offset:2048
    v_mul_f32 v138, v138, v26
    v_mfma_f32_16x16x32_bf16 v[148:151], a[116:119], a[224:227], v[148:151]
    ds_read_b128 v[76:79], v13 offset:2048
    v_fma_f32 v144, v144, v40, v48
    v_mfma_f32_16x16x32_bf16 v[148:151], a[92:95], a[220:223], v[148:151]
    ds_read_b128 v[80:83], v12 offset:4096
    v_fma_f32 v145, v145, v41, v49
    v_mfma_f32_16x16x32_bf16 v[148:151], a[68:71], a[216:219], v[148:151]
    ds_read_b128 v[84:87], v13 offset:4096
    v_fma_f32 v146, v146, v42, v50
    v_mfma_f32_16x16x32_bf16 v[148:151], a[60:63], v[96:99], v[148:151]
    v_rcp_f32 v27, v27
    v_mfma_f32_16x16x32_bf16 v[148:151], a[84:87], v[100:103], v[148:151]
    v_mul_f32 v139, v139, v27
    v_fma_f32 v147, v147, v43, v51
    v_mfma_f32_16x16x32_bf16 v[148:151], a[108:111], v[104:107], v[148:151]
    v_cvt_pk_bf16_f32 v139, v138, v139
    v_mfma_f32_16x16x32_bf16 v[148:151], a[132:135], v[108:111], v[148:151]
    v_cvt_pk_bf16_f32 v138, v136, v137
    v_mfma_f32_16x16x32_bf16 v[148:151], a[156:159], v[112:115], v[148:151]
    v_exp_f32 v16, v144
    v_mfma_f32_16x16x32_bf16 v[148:151], a[180:183], v[116:119], v[148:151]
    v_exp_f32 v17, v145
    v_mfma_f32_16x16x32_bf16 v[148:151], a[172:175], a[212:215], v[148:151]
    v_exp_f32 v18, v146
    v_mfma_f32_16x16x32_bf16 v[148:151], a[148:151], a[208:211], v[148:151]
    v_exp_f32 v19, v147
    v_mfma_f32_16x16x32_bf16 v[148:151], a[124:127], a[204:207], v[148:151]
    v_fma_f32 v16, v16, s34, s34
    v_fma_f32 v17, v17, s34, s34
    v_mfma_f32_16x16x32_bf16 v[148:151], a[100:103], a[200:203], v[148:151]
    v_fma_f32 v18, v18, s34, s34
    v_fma_f32 v19, v19, s34, s34
    v_mfma_f32_16x16x32_bf16 v[148:151], a[76:79], a[196:199], v[148:151]
    v_rcp_f32 v16, v16
    v_mfma_f32_16x16x32_bf16 v[148:151], a[52:55], a[192:195], v[148:151]
    v_rcp_f32 v17, v17
    v_mfma_f32_16x16x32_bf16 v[156:159], a[52:55], v[96:99], v[156:159]
    v_rcp_f32 v18, v18
    v_mfma_f32_16x16x32_bf16 v[156:159], a[76:79], v[100:103], v[156:159]
    v_rcp_f32 v19, v19
    v_mfma_f32_16x16x32_bf16 v[156:159], a[100:103], v[104:107], v[156:159]
    v_mul_f32 v144, v144, v16
    v_mul_f32 v145, v145, v17
    v_mfma_f32_16x16x32_bf16 v[156:159], a[124:127], v[108:111], v[156:159]
    v_mul_f32 v146, v146, v18
    v_mul_f32 v147, v147, v19
    v_mfma_f32_16x16x32_bf16 v[156:159], a[148:151], v[112:115], v[156:159]
    v_cvt_pk_bf16_f32 v147, v146, v147
    v_fma_f32 v148, v148, v44, v52
    v_mfma_f32_16x16x32_bf16 v[156:159], a[172:175], v[116:119], v[156:159]
    v_cvt_pk_bf16_f32 v146, v144, v145
    v_fma_f32 v149, v149, v45, v53
    v_mfma_f32_16x16x32_bf16 v[156:159], a[180:183], a[236:239], v[156:159]
    v_fma_f32 v150, v150, v46, v54
    v_fma_f32 v151, v151, v47, v55
    v_mfma_f32_16x16x32_bf16 v[156:159], a[156:159], a[232:235], v[156:159]
    v_exp_f32 v20, v148
    v_mfma_f32_16x16x32_bf16 v[156:159], a[132:135], a[228:231], v[156:159]
    v_exp_f32 v21, v149
    v_mfma_f32_16x16x32_bf16 v[156:159], a[108:111], a[224:227], v[156:159]
    v_exp_f32 v22, v150
    v_mfma_f32_16x16x32_bf16 v[156:159], a[84:87], a[220:223], v[156:159]
    v_exp_f32 v23, v151
    v_mfma_f32_16x16x32_bf16 v[156:159], a[60:63], a[216:219], v[156:159]
    s_waitcnt lgkmcnt(5)
    v_fma_f32 v20, v20, s34, s34
    v_fma_f32 v21, v21, s34, s34
    v_mfma_f32_16x16x32_bf16 v[156:159], a[68:71], v[64:67], v[156:159]
    s_waitcnt lgkmcnt(4)
    v_fma_f32 v22, v22, s34, s34
    v_fma_f32 v23, v23, s34, s34
    v_mfma_f32_16x16x32_bf16 v[156:159], a[92:95], v[68:71], v[156:159]
    s_waitcnt lgkmcnt(3)
    v_rcp_f32 v20, v20
    v_mfma_f32_16x16x32_bf16 v[156:159], a[116:119], v[72:75], v[156:159]
    s_waitcnt lgkmcnt(2)
    v_rcp_f32 v21, v21
    v_mfma_f32_16x16x32_bf16 v[156:159], a[140:143], v[76:79], v[156:159]
    s_waitcnt lgkmcnt(1)
    v_rcp_f32 v22, v22
    v_mfma_f32_16x16x32_bf16 v[156:159], a[164:167], v[80:83], v[156:159]
    s_waitcnt lgkmcnt(0)
    v_rcp_f32 v23, v23
    v_mfma_f32_16x16x32_bf16 v[156:159], a[188:191], v[84:87], v[156:159]
    v_mul_f32 v148, v148, v20
    v_mul_f32 v149, v149, v21
    v_mfma_f32_16x16x32_bf16 v[152:155], a[184:187], v[84:87], v[152:155]
    ds_read_b128 a[192:195], v12 offset:1024
    v_mul_f32 v150, v150, v22
    v_mfma_f32_16x16x32_bf16 v[152:155], a[160:163], v[80:83], v[152:155]
    ds_read_b128 a[196:199], v13 offset:1024
    v_mul_f32 v151, v151, v23
    v_mfma_f32_16x16x32_bf16 v[152:155], a[136:139], v[76:79], v[152:155]
    ds_read_b128 a[200:203], v12 offset:3072
    v_cvt_pk_bf16_f32 v148, v148, v149
    v_mfma_f32_16x16x32_bf16 v[152:155], a[112:115], v[72:75], v[152:155]
    ds_read_b128 a[204:207], v13 offset:3072
    v_cvt_pk_bf16_f32 v149, v150, v151
    v_mfma_f32_16x16x32_bf16 v[152:155], a[88:91], v[68:71], v[152:155]
    ds_read_b128 a[208:211], v12 offset:5120
    v_fma_f32 v156, v156, v44, v52
    v_mfma_f32_16x16x32_bf16 v[152:155], a[64:67], v[64:67], v[152:155]
    ds_read_b128 a[212:215], v13 offset:5120
    v_fma_f32 v157, v157, v45, v53
    v_mfma_f32_16x16x32_bf16 v[152:155], a[56:59], a[216:219], v[152:155]
    v_fma_f32 v158, v158, v46, v54
    v_fma_f32 v159, v159, v47, v55
    v_mfma_f32_16x16x32_bf16 v[152:155], a[80:83], a[220:223], v[152:155]
    v_exp_f32 v28, v156
    v_mfma_f32_16x16x32_bf16 v[152:155], a[104:107], a[224:227], v[152:155]
    v_exp_f32 v29, v157
    v_mfma_f32_16x16x32_bf16 v[152:155], a[128:131], a[228:231], v[152:155]
    v_exp_f32 v30, v158
    v_mfma_f32_16x16x32_bf16 v[152:155], a[152:155], a[232:235], v[152:155]
    v_exp_f32 v31, v159
    v_mfma_f32_16x16x32_bf16 v[152:155], a[176:179], a[236:239], v[152:155]
    v_fma_f32 v28, v28, s34, s34
    v_fma_f32 v29, v29, s34, s34
    v_mfma_f32_16x16x32_bf16 v[152:155], a[168:171], v[116:119], v[152:155]
    v_fma_f32 v30, v30, s34, s34
    v_fma_f32 v31, v31, s34, s34
    v_mfma_f32_16x16x32_bf16 v[152:155], a[144:147], v[112:115], v[152:155]
    v_rcp_f32 v28, v28
    v_mfma_f32_16x16x32_bf16 v[152:155], a[120:123], v[108:111], v[152:155]
    v_rcp_f32 v29, v29
    v_mfma_f32_16x16x32_bf16 v[152:155], a[96:99], v[104:107], v[152:155]
    v_rcp_f32 v30, v30
    v_mfma_f32_16x16x32_bf16 v[152:155], a[72:75], v[100:103], v[152:155]
    v_rcp_f32 v31, v31
    v_mfma_f32_16x16x32_bf16 v[152:155], a[48:51], v[96:99], v[152:155]
    v_mul_f32 v156, v156, v28
    v_mul_f32 v157, v157, v29
    v_mfma_f32_16x16x32_bf16 v[160:163], a[48:51], a[216:219], v[160:163]
    v_mul_f32 v158, v158, v30
    v_mul_f32 v159, v159, v31
    v_mfma_f32_16x16x32_bf16 v[160:163], a[72:75], a[220:223], v[160:163]
    v_cvt_pk_bf16_f32 v156, v156, v157
    v_mfma_f32_16x16x32_bf16 v[160:163], a[96:99], a[224:227], v[160:163]
    v_cvt_pk_bf16_f32 v157, v158, v159
    v_fma_f32 v152, v152, v40, v48
    v_mfma_f32_16x16x32_bf16 v[160:163], a[120:123], a[228:231], v[160:163]
    s_waitcnt vmcnt(0)
    v_fma_f32 v153, v153, v41, v49
    v_fma_f32 v154, v154, v42, v50
    v_mfma_f32_16x16x32_bf16 v[160:163], a[144:147], a[232:235], v[160:163]
    s_barrier
    v_fma_f32 v155, v155, v43, v51
    v_mfma_f32_16x16x32_bf16 v[160:163], a[168:171], a[236:239], v[160:163]
    v_exp_f32 v24, v152
    v_mfma_f32_16x16x32_bf16 v[160:163], a[176:179], v[84:87], v[160:163]
    v_exp_f32 v25, v153
    v_mfma_f32_16x16x32_bf16 v[160:163], a[152:155], v[80:83], v[160:163]
    v_exp_f32 v26, v154
    v_mfma_f32_16x16x32_bf16 v[160:163], a[128:131], v[76:79], v[160:163]
    v_exp_f32 v27, v155
    v_mfma_f32_16x16x32_bf16 v[160:163], a[104:107], v[72:75], v[160:163]
    v_fma_f32 v24, v24, s34, s34
    v_fma_f32 v25, v25, s34, s34
    v_mfma_f32_16x16x32_bf16 v[160:163], a[80:83], v[68:71], v[160:163]
    v_fma_f32 v26, v26, s34, s34
    v_fma_f32 v27, v27, s34, s34
    v_mfma_f32_16x16x32_bf16 v[160:163], a[56:59], v[64:67], v[160:163]
    s_waitcnt lgkmcnt(5)
    v_rcp_f32 v24, v24
    v_mfma_f32_16x16x32_bf16 v[160:163], a[64:67], a[192:195], v[160:163]
    s_waitcnt lgkmcnt(4)
    v_rcp_f32 v25, v25
    v_mfma_f32_16x16x32_bf16 v[160:163], a[88:91], a[196:199], v[160:163]
    s_waitcnt lgkmcnt(3)
    v_rcp_f32 v26, v26
    v_mfma_f32_16x16x32_bf16 v[160:163], a[112:115], a[200:203], v[160:163]
    s_waitcnt lgkmcnt(2)
    v_rcp_f32 v27, v27
    v_mfma_f32_16x16x32_bf16 v[160:163], a[136:139], a[204:207], v[160:163]
    s_waitcnt lgkmcnt(1)
    v_mul_f32 v152, v152, v24
    v_mul_f32 v153, v153, v25
    v_mfma_f32_16x16x32_bf16 v[160:163], a[160:163], a[208:211], v[160:163]
    s_waitcnt lgkmcnt(0)
    v_mul_f32 v154, v154, v26
    v_mul_f32 v155, v155, v27
    v_mfma_f32_16x16x32_bf16 v[160:163], a[184:187], a[212:215], v[160:163]
    v_cvt_pk_bf16_f32 v155, v154, v155
    v_mfma_f32_16x16x32_bf16 v[164:167], a[188:191], a[212:215], v[164:167]
    ds_read_b128 v[96:99], v12 offset:12288
    v_cvt_pk_bf16_f32 v154, v152, v153
    v_mfma_f32_16x16x32_bf16 v[164:167], a[164:167], a[208:211], v[164:167]
    ds_read_b128 v[100:103], v13 offset:12288
    v_mfma_f32_16x16x32_bf16 v[164:167], a[140:143], a[204:207], v[164:167]
    ds_read_b128 v[104:107], v12 offset:14336
    v_fma_f32 v160, v160, v40, v48
    v_mfma_f32_16x16x32_bf16 v[164:167], a[116:119], a[200:203], v[164:167]
    ds_read_b128 v[108:111], v13 offset:14336
    v_fma_f32 v161, v161, v41, v49
    v_mfma_f32_16x16x32_bf16 v[164:167], a[92:95], a[196:199], v[164:167]
    ds_read_b128 v[112:115], v12 offset:16384
    v_fma_f32 v162, v162, v42, v50
    v_mfma_f32_16x16x32_bf16 v[164:167], a[68:71], a[192:195], v[164:167]
    ds_read_b128 v[116:119], v13 offset:16384
    v_fma_f32 v163, v163, v43, v51
    v_mfma_f32_16x16x32_bf16 v[164:167], a[60:63], v[64:67], v[164:167]
    v_exp_f32 v16, v160
    v_mfma_f32_16x16x32_bf16 v[164:167], a[84:87], v[68:71], v[164:167]
    v_exp_f32 v17, v161
    v_mfma_f32_16x16x32_bf16 v[164:167], a[108:111], v[72:75], v[164:167]
    v_exp_f32 v18, v162
    v_mfma_f32_16x16x32_bf16 v[164:167], a[132:135], v[76:79], v[164:167]
    v_exp_f32 v19, v163
    v_mfma_f32_16x16x32_bf16 v[164:167], a[156:159], v[80:83], v[164:167]
    v_fma_f32 v16, v16, s34, s34
    v_fma_f32 v17, v17, s34, s34
    v_mfma_f32_16x16x32_bf16 v[164:167], a[180:183], v[84:87], v[164:167]
    v_fma_f32 v18, v18, s34, s34
    v_fma_f32 v19, v19, s34, s34
    v_mfma_f32_16x16x32_bf16 v[164:167], a[172:175], a[236:239], v[164:167]
    v_rcp_f32 v16, v16
    v_mfma_f32_16x16x32_bf16 v[164:167], a[148:151], a[232:235], v[164:167]
    v_rcp_f32 v17, v17
    v_mfma_f32_16x16x32_bf16 v[164:167], a[124:127], a[228:231], v[164:167]
    v_rcp_f32 v18, v18
    v_mfma_f32_16x16x32_bf16 v[164:167], a[100:103], a[224:227], v[164:167]
    v_rcp_f32 v19, v19
    v_mfma_f32_16x16x32_bf16 v[164:167], a[76:79], a[220:223], v[164:167]
    v_mul_f32 v160, v160, v16
    v_mul_f32 v161, v161, v17
    v_mfma_f32_16x16x32_bf16 v[164:167], a[52:55], a[216:219], v[164:167]
    v_mul_f32 v162, v162, v18
    v_mul_f32 v163, v163, v19
    v_mfma_f32_16x16x32_bf16 v[172:175], a[52:55], v[64:67], v[172:175]
    v_cvt_pk_bf16_f32 v163, v162, v163
    v_mfma_f32_16x16x32_bf16 v[172:175], a[76:79], v[68:71], v[172:175]
    v_cvt_pk_bf16_f32 v162, v160, v161
    v_mfma_f32_16x16x32_bf16 v[172:175], a[100:103], v[72:75], v[172:175]
    v_mfma_f32_16x16x32_bf16 v[172:175], a[124:127], v[76:79], v[172:175]
    v_fma_f32 v164, v164, v44, v52
    v_fma_f32 v165, v165, v45, v53
    v_mfma_f32_16x16x32_bf16 v[172:175], a[148:151], v[80:83], v[172:175]
    v_fma_f32 v166, v166, v46, v54
    v_fma_f32 v167, v167, v47, v55
    v_mfma_f32_16x16x32_bf16 v[172:175], a[172:175], v[84:87], v[172:175]
    v_exp_f32 v20, v164
    v_mfma_f32_16x16x32_bf16 v[172:175], a[180:183], a[212:215], v[172:175]
    v_exp_f32 v21, v165
    v_mfma_f32_16x16x32_bf16 v[172:175], a[156:159], a[208:211], v[172:175]
    v_exp_f32 v22, v166
    v_mfma_f32_16x16x32_bf16 v[172:175], a[132:135], a[204:207], v[172:175]
    v_exp_f32 v23, v167
    v_mfma_f32_16x16x32_bf16 v[172:175], a[108:111], a[200:203], v[172:175]
    v_fma_f32 v20, v20, s34, s34
    v_fma_f32 v21, v21, s34, s34
    v_mfma_f32_16x16x32_bf16 v[172:175], a[84:87], a[196:199], v[172:175]
    v_fma_f32 v22, v22, s34, s34
    v_fma_f32 v23, v23, s34, s34
    v_mfma_f32_16x16x32_bf16 v[172:175], a[60:63], a[192:195], v[172:175]
    s_waitcnt lgkmcnt(5)
    v_rcp_f32 v20, v20
    v_mfma_f32_16x16x32_bf16 v[172:175], a[68:71], v[96:99], v[172:175]
    s_waitcnt lgkmcnt(4)
    v_rcp_f32 v21, v21
    v_mfma_f32_16x16x32_bf16 v[172:175], a[92:95], v[100:103], v[172:175]
    s_waitcnt lgkmcnt(3)
    v_rcp_f32 v22, v22
    v_mfma_f32_16x16x32_bf16 v[172:175], a[116:119], v[104:107], v[172:175]
    s_waitcnt lgkmcnt(2)
    v_rcp_f32 v23, v23
    v_mfma_f32_16x16x32_bf16 v[172:175], a[140:143], v[108:111], v[172:175]
    s_waitcnt lgkmcnt(1)
    v_mul_f32 v164, v164, v20
    v_mul_f32 v165, v165, v21
    v_mfma_f32_16x16x32_bf16 v[172:175], a[164:167], v[112:115], v[172:175]
    s_waitcnt lgkmcnt(0)
    v_mul_f32 v166, v166, v22
    v_mul_f32 v167, v167, v23
    v_mfma_f32_16x16x32_bf16 v[172:175], a[188:191], v[116:119], v[172:175]
    v_cvt_pk_bf16_f32 v164, v164, v165
    v_mfma_f32_16x16x32_bf16 v[168:171], a[184:187], v[116:119], v[168:171]
    ds_read_b128 a[216:219], v12 offset:13312
    v_cvt_pk_bf16_f32 v165, v166, v167
    v_mfma_f32_16x16x32_bf16 v[168:171], a[160:163], v[112:115], v[168:171]
    ds_read_b128 a[220:223], v13 offset:13312
    v_mfma_f32_16x16x32_bf16 v[168:171], a[136:139], v[108:111], v[168:171]
    ds_read_b128 a[224:227], v12 offset:15360
    v_fma_f32 v172, v172, v44, v52
    v_mfma_f32_16x16x32_bf16 v[168:171], a[112:115], v[104:107], v[168:171]
    ds_read_b128 a[228:231], v13 offset:15360
    v_fma_f32 v173, v173, v45, v53
    v_mfma_f32_16x16x32_bf16 v[168:171], a[88:91], v[100:103], v[168:171]
    ds_read_b128 a[232:235], v12 offset:17408
    v_fma_f32 v174, v174, v46, v54
    v_mfma_f32_16x16x32_bf16 v[168:171], a[64:67], v[96:99], v[168:171]
    ds_read_b128 a[236:239], v13 offset:17408
    v_fma_f32 v175, v175, v47, v55
    v_mfma_f32_16x16x32_bf16 v[168:171], a[56:59], a[192:195], v[168:171]
    v_exp_f32 v28, v172
    v_mfma_f32_16x16x32_bf16 v[168:171], a[80:83], a[196:199], v[168:171]
    v_exp_f32 v29, v173
    v_mfma_f32_16x16x32_bf16 v[168:171], a[104:107], a[200:203], v[168:171]
    v_exp_f32 v30, v174
    v_mfma_f32_16x16x32_bf16 v[168:171], a[128:131], a[204:207], v[168:171]
    v_exp_f32 v31, v175
    v_mfma_f32_16x16x32_bf16 v[168:171], a[152:155], a[208:211], v[168:171]
    v_fma_f32 v28, v28, s34, s34
    v_fma_f32 v29, v29, s34, s34
    v_mfma_f32_16x16x32_bf16 v[168:171], a[176:179], a[212:215], v[168:171]
    v_fma_f32 v30, v30, s34, s34
    v_fma_f32 v31, v31, s34, s34
    v_mfma_f32_16x16x32_bf16 v[168:171], a[168:171], v[84:87], v[168:171]
    v_rcp_f32 v28, v28
    v_mfma_f32_16x16x32_bf16 v[168:171], a[144:147], v[80:83], v[168:171]
    v_rcp_f32 v29, v29
    v_mfma_f32_16x16x32_bf16 v[168:171], a[120:123], v[76:79], v[168:171]
    buffer_store_dwordx4 v[130:133], v10, s[16:19], 0 offen offset:0 sc1 nt
    v_mfma_f32_16x16x32_bf16 v[168:171], a[96:99], v[72:75], v[168:171]
    v_rcp_f32 v30, v30
    v_mfma_f32_16x16x32_bf16 v[168:171], a[72:75], v[68:71], v[168:171]
    v_rcp_f32 v31, v31
    v_mfma_f32_16x16x32_bf16 v[168:171], a[48:51], v[64:67], v[168:171]
    v_mul_f32 v172, v172, v28
    v_mul_f32 v173, v173, v29
    v_mfma_f32_16x16x32_bf16 v[176:179], a[48:51], a[192:195], v[176:179]
    v_mul_f32 v174, v174, v30
    v_mul_f32 v175, v175, v31
    v_mfma_f32_16x16x32_bf16 v[176:179], a[72:75], a[196:199], v[176:179]
    v_cvt_pk_bf16_f32 v172, v172, v173
    v_mfma_f32_16x16x32_bf16 v[176:179], a[96:99], a[200:203], v[176:179]
    v_cvt_pk_bf16_f32 v173, v174, v175
    v_fma_f32 v168, v168, v40, v48
    v_mfma_f32_16x16x32_bf16 v[176:179], a[120:123], a[204:207], v[176:179]
    v_fma_f32 v169, v169, v41, v49
    v_fma_f32 v170, v170, v42, v50
    v_mfma_f32_16x16x32_bf16 v[176:179], a[144:147], a[208:211], v[176:179]
    v_fma_f32 v171, v171, v43, v51
    v_mfma_f32_16x16x32_bf16 v[176:179], a[168:171], a[212:215], v[176:179]
    v_exp_f32 v24, v168
    v_mfma_f32_16x16x32_bf16 v[176:179], a[176:179], v[116:119], v[176:179]
    v_exp_f32 v25, v169
    v_mfma_f32_16x16x32_bf16 v[176:179], a[152:155], v[112:115], v[176:179]
    v_exp_f32 v26, v170
    v_mfma_f32_16x16x32_bf16 v[176:179], a[128:131], v[108:111], v[176:179]
    v_exp_f32 v27, v171
    v_mfma_f32_16x16x32_bf16 v[176:179], a[104:107], v[104:107], v[176:179]
    v_fma_f32 v24, v24, s34, s34
    v_fma_f32 v25, v25, s34, s34
    v_mfma_f32_16x16x32_bf16 v[176:179], a[80:83], v[100:103], v[176:179]
    v_fma_f32 v26, v26, s34, s34
    v_fma_f32 v27, v27, s34, s34
    v_mfma_f32_16x16x32_bf16 v[176:179], a[56:59], v[96:99], v[176:179]
    s_waitcnt lgkmcnt(5)
    v_rcp_f32 v24, v24
    v_mfma_f32_16x16x32_bf16 v[176:179], a[64:67], a[216:219], v[176:179]
    s_waitcnt lgkmcnt(4)
    v_rcp_f32 v25, v25
    v_mfma_f32_16x16x32_bf16 v[176:179], a[88:91], a[220:223], v[176:179]
    s_waitcnt lgkmcnt(3)
    v_rcp_f32 v26, v26
    v_mfma_f32_16x16x32_bf16 v[176:179], a[112:115], a[224:227], v[176:179]
    s_waitcnt lgkmcnt(2)
    v_rcp_f32 v27, v27
    v_mfma_f32_16x16x32_bf16 v[176:179], a[136:139], a[228:231], v[176:179]
    s_waitcnt lgkmcnt(1)
    v_mul_f32 v168, v168, v24
    v_mul_f32 v169, v169, v25
    v_mfma_f32_16x16x32_bf16 v[176:179], a[160:163], a[232:235], v[176:179]
    s_waitcnt lgkmcnt(0)
    v_mul_f32 v170, v170, v26
    v_mul_f32 v171, v171, v27
    v_mfma_f32_16x16x32_bf16 v[176:179], a[184:187], a[236:239], v[176:179]
    buffer_store_dwordx4 v[138:141], v10, s[16:19], 0 offen offset:1024 sc1 nt
    v_mfma_f32_16x16x32_bf16 v[180:183], a[188:191], a[236:239], v[180:183]
    ds_read_b128 v[64:67], v12 offset:24576
    v_cvt_pk_bf16_f32 v171, v170, v171
    v_mfma_f32_16x16x32_bf16 v[180:183], a[164:167], a[232:235], v[180:183]
    ds_read_b128 v[68:71], v13 offset:24576
    v_cvt_pk_bf16_f32 v170, v168, v169
    v_mfma_f32_16x16x32_bf16 v[180:183], a[140:143], a[228:231], v[180:183]
    ds_read_b128 v[72:75], v12 offset:26624
L_stub4:
    s_cbranch_vccnz L_back1
    v_fma_f32 v176, v176, v40, v48
    v_mfma_f32_16x16x32_bf16 v[180:183], a[116:119], a[224:227], v[180:183]
    ds_read_b128 v[76:79], v13 offset:26624
    v_fma_f32 v177, v177, v41, v49
    v_mfma_f32_16x16x32_bf16 v[180:183], a[92:95], a[220:223], v[180:183]
    ds_read_b128 v[80:83], v12 offset:28672
    v_fma_f32 v178, v178, v42, v50
    v_mfma_f32_16x16x32_bf16 v[180:183], a[68:71], a[216:219], v[180:183]
    ds_read_b128 v[84:87], v13 offset:28672
    v_fma_f32 v179, v179, v43, v51
    v_mfma_f32_16x16x32_bf16 v[180:183], a[60:63], v[96:99], v[180:183]
    v_exp_f32 v16, v176
    v_mfma_f32_16x16x32_bf16 v[180:183], a[84:87], v[100:103], v[180:183]
    v_exp_f32 v17, v177
    v_mfma_f32_16x16x32_bf16 v[180:183], a[108:111], v[104:107], v[180:183]
    v_exp_f32 v18, v178
    v_mfma_f32_16x16x32_bf16 v[180:183], a[132:135], v[108:111], v[180:183]
    v_exp_f32 v19, v179
    v_mfma_f32_16x16x32_bf16 v[180:183], a[156:159], v[112:115], v[180:183]
    v_fma_f32 v16, v16, s34, s34
    v_fma_f32 v17, v17, s34, s34
    v_mfma_f32_16x16x32_bf16 v[180:183], a[180:183], v[116:119], v[180:183]
    v_fma_f32 v18, v18, s34, s34
    v_fma_f32 v19, v19, s34, s34
    v_mfma_f32_16x16x32_bf16 v[180:183], a[172:175], a[212:215], v[180:183]
    v_rcp_f32 v16, v16
    v_mfma_f32_16x16x32_bf16 v[180:183], a[148:151], a[208:211], v[180:183]
    v_rcp_f32 v17, v17
    v_mfma_f32_16x16x32_bf16 v[180:183], a[124:127], a[204:207], v[180:183]
    v_rcp_f32 v18, v18
    v_mfma_f32_16x16x32_bf16 v[180:183], a[100:103], a[200:203], v[180:183]
    v_rcp_f32 v19, v19
    v_mfma_f32_16x16x32_bf16 v[180:183], a[76:79], a[196:199], v[180:183]
    v_mul_f32 v176, v176, v16
    v_mul_f32 v177, v177, v17
    v_mfma_f32_16x16x32_bf16 v[180:183], a[52:55], a[192:195], v[180:183]
    v_mul_f32 v178, v178, v18
    v_mul_f32 v179, v179, v19
    v_mfma_f32_16x16x32_bf16 v[188:191], a[52:55], v[96:99], v[188:191]
    v_cvt_pk_bf16_f32 v179, v178, v179
    v_mfma_f32_16x16x32_bf16 v[188:191], a[76:79], v[100:103], v[188:191]
    buffer_store_dwordx4 v[146:149], v10, s[16:19], 0 offen offset:2048 sc1 nt
    v_mfma_f32_16x16x32_bf16 v[188:191], a[100:103], v[104:107], v[188:191]
    v_cvt_pk_bf16_f32 v178, v176, v177
    v_fma_f32 v180, v180, v44, v52
    v_mfma_f32_16x16x32_bf16 v[188:191], a[124:127], v[108:111], v[188:191]
    v_fma_f32 v181, v181, v45, v53
    v_fma_f32 v182, v182, v46, v54
    v_mfma_f32_16x16x32_bf16 v[188:191], a[148:151], v[112:115], v[188:191]
    v_fma_f32 v183, v183, v47, v55
    v_mfma_f32_16x16x32_bf16 v[188:191], a[172:175], v[116:119], v[188:191]
    v_exp_f32 v20, v180
    v_mfma_f32_16x16x32_bf16 v[188:191], a[180:183], a[236:239], v[188:191]
    v_exp_f32 v21, v181
    v_mfma_f32_16x16x32_bf16 v[188:191], a[156:159], a[232:235], v[188:191]
    v_exp_f32 v22, v182
    v_mfma_f32_16x16x32_bf16 v[188:191], a[132:135], a[228:231], v[188:191]
    v_exp_f32 v23, v183
    v_mfma_f32_16x16x32_bf16 v[188:191], a[108:111], a[224:227], v[188:191]
    v_fma_f32 v20, v20, s34, s34
    v_fma_f32 v21, v21, s34, s34
    v_mfma_f32_16x16x32_bf16 v[188:191], a[84:87], a[220:223], v[188:191]
    v_fma_f32 v22, v22, s34, s34
    v_fma_f32 v23, v23, s34, s34
    v_mfma_f32_16x16x32_bf16 v[188:191], a[60:63], a[216:219], v[188:191]
    s_waitcnt lgkmcnt(5)
    v_rcp_f32 v20, v20
    v_mfma_f32_16x16x32_bf16 v[188:191], a[68:71], v[64:67], v[188:191]
    s_waitcnt lgkmcnt(4)
    v_rcp_f32 v21, v21
    v_mfma_f32_16x16x32_bf16 v[188:191], a[92:95], v[68:71], v[188:191]
    s_waitcnt lgkmcnt(3)
    v_rcp_f32 v22, v22
    v_mfma_f32_16x16x32_bf16 v[188:191], a[116:119], v[72:75], v[188:191]
    s_waitcnt lgkmcnt(2)
    v_rcp_f32 v23, v23
    v_mfma_f32_16x16x32_bf16 v[188:191], a[140:143], v[76:79], v[188:191]
    s_waitcnt lgkmcnt(1)
    v_mul_f32 v180, v180, v20
    v_mul_f32 v181, v181, v21
    v_mfma_f32_16x16x32_bf16 v[188:191], a[164:167], v[80:83], v[188:191]
    s_waitcnt lgkmcnt(0)
    v_mul_f32 v182, v182, v22
    v_mul_f32 v183, v183, v23
    v_mfma_f32_16x16x32_bf16 v[188:191], a[188:191], v[84:87], v[188:191]
    v_cvt_pk_bf16_f32 v180, v180, v181
    v_mfma_f32_16x16x32_bf16 v[184:187], a[184:187], v[84:87], v[184:187]
    ds_read_b128 a[192:195], v12 offset:25600
    v_cvt_pk_bf16_f32 v181, v182, v183
    v_mfma_f32_16x16x32_bf16 v[184:187], a[160:163], v[80:83], v[184:187]
    ds_read_b128 a[196:199], v13 offset:25600
    v_mfma_f32_16x16x32_bf16 v[184:187], a[136:139], v[76:79], v[184:187]
    ds_read_b128 a[200:203], v12 offset:27648
    v_fma_f32 v188, v188, v44, v52
    v_mfma_f32_16x16x32_bf16 v[184:187], a[112:115], v[72:75], v[184:187]
    buffer_store_dwordx4 v[154:157], v10, s[16:19], 0 offen offset:3072 sc1 nt
    v_mfma_f32_16x16x32_bf16 v[184:187], a[88:91], v[68:71], v[184:187]
    ds_read_b128 a[204:207], v13 offset:27648
    v_fma_f32 v189, v189, v45, v53
    v_mfma_f32_16x16x32_bf16 v[184:187], a[64:67], v[64:67], v[184:187]
    ds_read_b128 a[208:211], v12 offset:29696
    v_fma_f32 v190, v190, v46, v54
    v_mfma_f32_16x16x32_bf16 v[184:187], a[56:59], a[216:219], v[184:187]
    ds_read_b128 a[212:215], v13 offset:29696
    v_fma_f32 v191, v191, v47, v55
    v_mfma_f32_16x16x32_bf16 v[184:187], a[80:83], a[220:223], v[184:187]
    v_exp_f32 v28, v188
    v_mfma_f32_16x16x32_bf16 v[184:187], a[104:107], a[224:227], v[184:187]
    v_exp_f32 v29, v189
    v_mfma_f32_16x16x32_bf16 v[184:187], a[128:131], a[228:231], v[184:187]
    v_exp_f32 v30, v190
    v_mfma_f32_16x16x32_bf16 v[184:187], a[152:155], a[232:235], v[184:187]
    v_exp_f32 v31, v191
    v_mfma_f32_16x16x32_bf16 v[184:187], a[176:179], a[236:239], v[184:187]
    v_fma_f32 v28, v28, s34, s34
    v_fma_f32 v29, v29, s34, s34
    v_mfma_f32_16x16x32_bf16 v[184:187], a[168:171], v[116:119], v[184:187]
    v_fma_f32 v30, v30, s34, s34
    v_fma_f32 v31, v31, s34, s34
    v_mfma_f32_16x16x32_bf16 v[184:187], a[144:147], v[112:115], v[184:187]
    v_rcp_f32 v28, v28
    v_mfma_f32_16x16x32_bf16 v[184:187], a[120:123], v[108:111], v[184:187]
    v_rcp_f32 v29, v29
    v_mfma_f32_16x16x32_bf16 v[184:187], a[96:99], v[104:107], v[184:187]
    v_rcp_f32 v30, v30
    v_mfma_f32_16x16x32_bf16 v[184:187], a[72:75], v[100:103], v[184:187]
    v_rcp_f32 v31, v31
    v_mfma_f32_16x16x32_bf16 v[184:187], a[48:51], v[96:99], v[184:187]
    v_mul_f32 v188, v188, v28
    v_mul_f32 v189, v189, v29
    v_mfma_f32_16x16x32_bf16 v[192:195], a[48:51], a[216:219], v[192:195]
    v_mul_f32 v190, v190, v30
    v_mul_f32 v191, v191, v31
    v_mfma_f32_16x16x32_bf16 v[192:195], a[72:75], a[220:223], v[192:195]
    v_cvt_pk_bf16_f32 v188, v188, v189
    v_mfma_f32_16x16x32_bf16 v[192:195], a[96:99], a[224:227], v[192:195]
    v_cvt_pk_bf16_f32 v189, v190, v191
    v_fma_f32 v184, v184, v40, v48
    v_mfma_f32_16x16x32_bf16 v[192:195], a[120:123], a[228:231], v[192:195]
    v_fma_f32 v185, v185, v41, v49
    v_fma_f32 v186, v186, v42, v50
    v_mfma_f32_16x16x32_bf16 v[192:195], a[144:147], a[232:235], v[192:195]
    v_fma_f32 v187, v187, v43, v51
    v_mfma_f32_16x16x32_bf16 v[192:195], a[168:171], a[236:239], v[192:195]
    buffer_store_dwordx4 v[162:165], v10, s[16:19], s36 offen offset:0 sc1 nt
    v_mfma_f32_16x16x32_bf16 v[192:195], a[176:179], v[84:87], v[192:195]
    v_exp_f32 v24, v184
    v_mfma_f32_16x16x32_bf16 v[192:195], a[152:155], v[80:83], v[192:195]
    v_exp_f32 v25, v185
    v_mfma_f32_16x16x32_bf16 v[192:195], a[128:131], v[76:79], v[192:195]
    v_exp_f32 v26, v186
    v_mfma_f32_16x16x32_bf16 v[192:195], a[104:107], v[72:75], v[192:195]
    v_exp_f32 v27, v187
    v_mfma_f32_16x16x32_bf16 v[192:195], a[80:83], v[68:71], v[192:195]
    v_fma_f32 v24, v24, s34, s34
    v_fma_f32 v25, v25, s34, s34
    v_mfma_f32_16x16x32_bf16 v[192:195], a[56:59], v[64:67], v[192:195]
    s_waitcnt lgkmcnt(5)
    v_fma_f32 v26, v26, s34, s34
    v_fma_f32 v27, v27, s34, s34
    v_mfma_f32_16x16x32_bf16 v[192:195], a[64:67], a[192:195], v[192:195]
    s_waitcnt lgkmcnt(4)
    v_rcp_f32 v24, v24
    v_mfma_f32_16x16x32_bf16 v[192:195], a[88:91], a[196:199], v[192:195]
    s_waitcnt lgkmcnt(3)
    v_rcp_f32 v25, v25
    v_mfma_f32_16x16x32_bf16 v[192:195], a[112:115], a[200:203], v[192:195]
    s_waitcnt lgkmcnt(2)
    v_rcp_f32 v26, v26
    v_mfma_f32_16x16x32_bf16 v[192:195], a[136:139], a[204:207], v[192:195]
    s_waitcnt lgkmcnt(1)
    v_rcp_f32 v27, v27
    v_mfma_f32_16x16x32_bf16 v[192:195], a[160:163], a[208:211], v[192:195]
    s_waitcnt lgkmcnt(0)
    v_mul_f32 v184, v184, v24
    v_mul_f32 v185, v185, v25
    v_mfma_f32_16x16x32_bf16 v[192:195], a[184:187], a[212:215], v[192:195]
    v_mul_f32 v186, v186, v26
    v_mul_f32 v187, v187, v27
    v_mfma_f32_16x16x32_bf16 v[196:199], a[188:191], a[212:215], v[196:199]
    ds_read_b128 v[96:99], v12 offset:36864
    v_cvt_pk_bf16_f32 v187, v186, v187
    v_mfma_f32_16x16x32_bf16 v[196:199], a[164:167], a[208:211], v[196:199]
    ds_read_b128 v[100:103], v13 offset:36864
    v_cvt_pk_bf16_f32 v186, v184, v185
    v_mfma_f32_16x16x32_bf16 v[196:199], a[140:143], a[204:207], v[196:199]
    ds_read_b128 v[104:107], v12 offset:38912
    v_fma_f32 v192, v192, v40, v48
    v_mfma_f32_16x16x32_bf16 v[196:199], a[116:119], a[200:203], v[196:199]
    ds_read_b128 v[108:111], v13 offset:38912
    v_fma_f32 v193, v193, v41, v49
    v_mfma_f32_16x16x32_bf16 v[196:199], a[92:95], a[196:199], v[196:199]
    ds_read_b128 v[112:115], v12 offset:40960
    v_fma_f32 v194, v194, v42, v50
    v_mfma_f32_16x16x32_bf16 v[196:199], a[68:71], a[192:195], v[196:199]
    ds_read_b128 v[116:119], v13 offset:40960
    v_fma_f32 v195, v195, v43, v51
    v_mfma_f32_16x16x32_bf16 v[196:199], a[60:63], v[64:67], v[196:199]
    v_exp_f32 v16, v192
    v_mfma_f32_16x16x32_bf16 v[196:199], a[84:87], v[68:71], v[196:199]
    buffer_store_dwordx4 v[170:173], v10, s[16:19], s36 offen offset:1024 sc1 nt
    v_mfma_f32_16x16x32_bf16 v[196:199], a[108:111], v[72:75], v[196:199]
    v_exp_f32 v17, v193
    v_mfma_f32_16x16x32_bf16 v[196:199], a[132:135], v[76:79], v[196:199]
    v_exp_f32 v18, v194
    v_mfma_f32_16x16x32_bf16 v[196:199], a[156:159], v[80:83], v[196:199]
    v_exp_f32 v19, v195
    v_mfma_f32_16x16x32_bf16 v[196:199], a[180:183], v[84:87], v[196:199]
    v_fma_f32 v16, v16, s34, s34
    v_fma_f32 v17, v17, s34, s34
    v_mfma_f32_16x16x32_bf16 v[196:199], a[172:175], a[236:239], v[196:199]
    v_fma_f32 v18, v18, s34, s34
    v_fma_f32 v19, v19, s34, s34
    v_mfma_f32_16x16x32_bf16 v[196:199], a[148:151], a[232:235], v[196:199]
    v_rcp_f32 v16, v16
    v_mfma_f32_16x16x32_bf16 v[196:199], a[124:127], a[228:231], v[196:199]
    v_rcp_f32 v17, v17
    v_mfma_f32_16x16x32_bf16 v[196:199], a[100:103], a[224:227], v[196:199]
    v_rcp_f32 v18, v18
    v_mfma_f32_16x16x32_bf16 v[196:199], a[76:79], a[220:223], v[196:199]
    v_rcp_f32 v19, v19
    v_mfma_f32_16x16x32_bf16 v[196:199], a[52:55], a[216:219], v[196:199]
    v_mul_f32 v192, v192, v16
    v_mul_f32 v193, v193, v17
    v_mfma_f32_16x16x32_bf16 v[204:207], a[52:55], v[64:67], v[204:207]
    v_mul_f32 v194, v194, v18
    v_mul_f32 v195, v195, v19
    v_mfma_f32_16x16x32_bf16 v[204:207], a[76:79], v[68:71], v[204:207]
    v_cvt_pk_bf16_f32 v195, v194, v195
    v_mfma_f32_16x16x32_bf16 v[204:207], a[100:103], v[72:75], v[204:207]
    v_cvt_pk_bf16_f32 v194, v192, v193
    v_fma_f32 v196, v196, v44, v52
    v_mfma_f32_16x16x32_bf16 v[204:207], a[124:127], v[76:79], v[204:207]
    v_fma_f32 v197, v197, v45, v53
    v_fma_f32 v198, v198, v46, v54
    v_mfma_f32_16x16x32_bf16 v[204:207], a[148:151], v[80:83], v[204:207]
    v_fma_f32 v199, v199, v47, v55
    v_mfma_f32_16x16x32_bf16 v[204:207], a[172:175], v[84:87], v[204:207]
    v_exp_f32 v20, v196
    v_mfma_f32_16x16x32_bf16 v[204:207], a[180:183], a[212:215], v[204:207]
    v_exp_f32 v21, v197
    v_mfma_f32_16x16x32_bf16 v[204:207], a[156:159], a[208:211], v[204:207]
    v_exp_f32 v22, v198
    v_mfma_f32_16x16x32_bf16 v[204:207], a[132:135], a[204:207], v[204:207]
    v_exp_f32 v23, v199
    v_mfma_f32_16x16x32_bf16 v[204:207], a[108:111], a[200:203], v[204:207]
    buffer_store_dwordx4 v[178:181], v10, s[16:19], s36 offen offset:2048 sc1 nt
    v_mfma_f32_16x16x32_bf16 v[204:207], a[84:87], a[196:199], v[204:207]
    v_fma_f32 v20, v20, s34, s34
    v_fma_f32 v21, v21, s34, s34
    v_mfma_f32_16x16x32_bf16 v[204:207], a[60:63], a[192:195], v[204:207]
    s_waitcnt lgkmcnt(5)
    v_fma_f32 v22, v22, s34, s34
    v_fma_f32 v23, v23, s34, s34
    v_mfma_f32_16x16x32_bf16 v[204:207], a[68:71], v[96:99], v[204:207]
    s_waitcnt lgkmcnt(4)
    v_rcp_f32 v20, v20
    v_mfma_f32_16x16x32_bf16 v[204:207], a[92:95], v[100:103], v[204:207]
    s_waitcnt lgkmcnt(3)
    v_rcp_f32 v21, v21
    v_mfma_f32_16x16x32_bf16 v[204:207], a[116:119], v[104:107], v[204:207]
    s_waitcnt lgkmcnt(2)
    v_rcp_f32 v22, v22
    v_mfma_f32_16x16x32_bf16 v[204:207], a[140:143], v[108:111], v[204:207]
    s_waitcnt lgkmcnt(1)
    v_rcp_f32 v23, v23
    v_mfma_f32_16x16x32_bf16 v[204:207], a[164:167], v[112:115], v[204:207]
    s_waitcnt lgkmcnt(0)
    v_mul_f32 v196, v196, v20
    v_mul_f32 v197, v197, v21
    v_mfma_f32_16x16x32_bf16 v[204:207], a[188:191], v[116:119], v[204:207]
    v_mul_f32 v198, v198, v22
    v_mul_f32 v199, v199, v23
    v_mfma_f32_16x16x32_bf16 v[200:203], a[184:187], v[116:119], v[200:203]
    ds_read_b128 a[216:219], v12 offset:37888
    v_cvt_pk_bf16_f32 v196, v196, v197
    v_mfma_f32_16x16x32_bf16 v[200:203], a[160:163], v[112:115], v[200:203]
    ds_read_b128 a[220:223], v13 offset:37888
    v_cvt_pk_bf16_f32 v197, v198, v199
    v_mfma_f32_16x16x32_bf16 v[200:203], a[136:139], v[108:111], v[200:203]
    ds_read_b128 a[224:227], v12 offset:39936
    v_fma_f32 v204, v204, v44, v52
    v_mfma_f32_16x16x32_bf16 v[200:203], a[112:115], v[104:107], v[200:203]
    ds_read_b128 a[228:231], v13 offset:39936
    v_fma_f32 v205, v205, v45, v53
    v_mfma_f32_16x16x32_bf16 v[200:203], a[88:91], v[100:103], v[200:203]
    ds_read_b128 a[232:235], v12 offset:41984
    v_fma_f32 v206, v206, v46, v54
    v_mfma_f32_16x16x32_bf16 v[200:203], a[64:67], v[96:99], v[200:203]
    ds_read_b128 a[236:239], v13 offset:41984
    v_fma_f32 v207, v207, v47, v55
    v_mfma_f32_16x16x32_bf16 v[200:203], a[56:59], a[192:195], v[200:203]
    v_exp_f32 v28, v204
    v_mfma_f32_16x16x32_bf16 v[200:203], a[80:83], a[196:199], v[200:203]
    v_exp_f32 v29, v205
    v_mfma_f32_16x16x32_bf16 v[200:203], a[104:107], a[200:203], v[200:203]
    v_exp_f32 v30, v206
    v_mfma_f32_16x16x32_bf16 v[200:203], a[128:131], a[204:207], v[200:203]
    v_exp_f32 v31, v207
    v_mfma_f32_16x16x32_bf16 v[200:203], a[152:155], a[208:211], v[200:203]
    v_fma_f32 v28, v28, s34, s34
    v_fma_f32 v29, v29, s34, s34
    v_mfma_f32_16x16x32_bf16 v[200:203], a[176:179], a[212:215], v[200:203]
    buffer_store_dwordx4 v[186:189], v10, s[16:19], s36 offen offset:3072 sc1 nt
    v_mfma_f32_16x16x32_bf16 v[200:203], a[168:171], v[84:87], v[200:203]
    v_fma_f32 v30, v30, s34, s34
    v_fma_f32 v31, v31, s34, s34
    v_mfma_f32_16x16x32_bf16 v[200:203], a[144:147], v[80:83], v[200:203]
    v_rcp_f32 v28, v28
    v_mfma_f32_16x16x32_bf16 v[200:203], a[120:123], v[76:79], v[200:203]
    v_rcp_f32 v29, v29
    v_mfma_f32_16x16x32_bf16 v[200:203], a[96:99], v[72:75], v[200:203]
    v_rcp_f32 v30, v30
    v_mfma_f32_16x16x32_bf16 v[200:203], a[72:75], v[68:71], v[200:203]
    v_rcp_f32 v31, v31
    v_mfma_f32_16x16x32_bf16 v[200:203], a[48:51], v[64:67], v[200:203]
    v_mul_f32 v204, v204, v28
    v_mul_f32 v205, v205, v29
    v_mfma_f32_16x16x32_bf16 v[208:211], a[48:51], a[192:195], v[208:211]
    v_mul_f32 v206, v206, v30
    v_mul_f32 v207, v207, v31
    v_mfma_f32_16x16x32_bf16 v[208:211], a[72:75], a[196:199], v[208:211]
    v_cvt_pk_bf16_f32 v204, v204, v205
    v_mfma_f32_16x16x32_bf16 v[208:211], a[96:99], a[200:203], v[208:211]
    v_cvt_pk_bf16_f32 v205, v206, v207
    v_fma_f32 v200, v200, v40, v48
    v_mfma_f32_16x16x32_bf16 v[208:211], a[120:123], a[204:207], v[208:211]
    v_fma_f32 v201, v201, v41, v49
    v_fma_f32 v202, v202, v42, v50
    v_mfma_f32_16x16x32_bf16 v[208:211], a[144:147], a[208:211], v[208:211]
    v_fma_f32 v203, v203, v43, v51
    v_mfma_f32_16x16x32_bf16 v[208:211], a[168:171], a[212:215], v[208:211]
    v_exp_f32 v24, v200
    v_mfma_f32_16x16x32_bf16 v[208:211], a[176:179], v[116:119], v[208:211]
    v_exp_f32 v25, v201
    v_mfma_f32_16x16x32_bf16 v[208:211], a[152:155], v[112:115], v[208:211]
    v_exp_f32 v26, v202
    v_mfma_f32_16x16x32_bf16 v[208:211], a[128:131], v[108:111], v[208:211]
    v_exp_f32 v27, v203
    v_mfma_f32_16x16x32_bf16 v[208:211], a[104:107], v[104:107], v[208:211]
    v_fma_f32 v24, v24, s34, s34
    v_fma_f32 v25, v25, s34, s34
    v_mfma_f32_16x16x32_bf16 v[208:211], a[80:83], v[100:103], v[208:211]
    v_fma_f32 v26, v26, s34, s34
    v_fma_f32 v27, v27, s34, s34
    v_mfma_f32_16x16x32_bf16 v[208:211], a[56:59], v[96:99], v[208:211]
    s_waitcnt lgkmcnt(5)
    v_rcp_f32 v24, v24
    v_mfma_f32_16x16x32_bf16 v[208:211], a[64:67], a[216:219], v[208:211]
    s_waitcnt lgkmcnt(4)
    v_rcp_f32 v25, v25
    v_mfma_f32_16x16x32_bf16 v[208:211], a[88:91], a[220:223], v[208:211]
    s_waitcnt lgkmcnt(3)
    v_rcp_f32 v26, v26
    v_mfma_f32_16x16x32_bf16 v[208:211], a[112:115], a[224:227], v[208:211]
    s_waitcnt lgkmcnt(2)
    v_rcp_f32 v27, v27
    v_mfma_f32_16x16x32_bf16 v[208:211], a[136:139], a[228:231], v[208:211]
    s_waitcnt lgkmcnt(1)
    v_mul_f32 v200, v200, v24
    v_mul_f32 v201, v201, v25
    v_mfma_f32_16x16x32_bf16 v[208:211], a[160:163], a[232:235], v[208:211]
    s_waitcnt lgkmcnt(0)
    v_mul_f32 v202, v202, v26
    v_mul_f32 v203, v203, v27
    v_mfma_f32_16x16x32_bf16 v[208:211], a[184:187], a[236:239], v[208:211]
    buffer_store_dwordx4 v[194:197], v10, s[16:19], s37 offen offset:0 sc1 nt
    v_mfma_f32_16x16x32_bf16 v[212:215], a[188:191], a[236:239], v[212:215]
    ds_read_b128 v[64:67], v12 offset:49152
    v_cvt_pk_bf16_f32 v203, v202, v203
    v_mfma_f32_16x16x32_bf16 v[212:215], a[164:167], a[232:235], v[212:215]
    ds_read_b128 v[68:71], v13 offset:49152
    v_cvt_pk_bf16_f32 v202, v200, v201
    v_mfma_f32_16x16x32_bf16 v[212:215], a[140:143], a[228:231], v[212:215]
    ds_read_b128 v[72:75], v12 offset:51200
    v_fma_f32 v208, v208, v40, v48
    v_mfma_f32_16x16x32_bf16 v[212:215], a[116:119], a[224:227], v[212:215]
    ds_read_b128 v[76:79], v13 offset:51200
    v_fma_f32 v209, v209, v41, v49
    v_mfma_f32_16x16x32_bf16 v[212:215], a[92:95], a[220:223], v[212:215]
    ds_read_b128 v[80:83], v12 offset:53248
    v_fma_f32 v210, v210, v42, v50
    v_mfma_f32_16x16x32_bf16 v[212:215], a[68:71], a[216:219], v[212:215]
    ds_read_b128 v[84:87], v13 offset:53248
    v_fma_f32 v211, v211, v43, v51
    v_mfma_f32_16x16x32_bf16 v[212:215], a[60:63], v[96:99], v[212:215]
    v_exp_f32 v16, v208
    v_mfma_f32_16x16x32_bf16 v[212:215], a[84:87], v[100:103], v[212:215]
    v_exp_f32 v17, v209
    v_mfma_f32_16x16x32_bf16 v[212:215], a[108:111], v[104:107], v[212:215]
    v_exp_f32 v18, v210
    v_mfma_f32_16x16x32_bf16 v[212:215], a[132:135], v[108:111], v[212:215]
    v_exp_f32 v19, v211
    v_mfma_f32_16x16x32_bf16 v[212:215], a[156:159], v[112:115], v[212:215]
    v_fma_f32 v16, v16, s34, s34
    v_fma_f32 v17, v17, s34, s34
    v_mfma_f32_16x16x32_bf16 v[212:215], a[180:183], v[116:119], v[212:215]
    v_fma_f32 v18, v18, s34, s34
    v_fma_f32 v19, v19, s34, s34
    v_mfma_f32_16x16x32_bf16 v[212:215], a[172:175], a[212:215], v[212:215]
    v_rcp_f32 v16, v16
    v_mfma_f32_16x16x32_bf16 v[212:215], a[148:151], a[208:211], v[212:215]
    v_rcp_f32 v17, v17
    v_mfma_f32_16x16x32_bf16 v[212:215], a[124:127], a[204:207], v[212:215]
    v_rcp_f32 v18, v18
    v_mfma_f32_16x16x32_bf16 v[212:215], a[100:103], a[200:203], v[212:215]
    v_rcp_f32 v19, v19
    v_mfma_f32_16x16x32_bf16 v[212:215], a[76:79], a[196:199], v[212:215]
    v_mul_f32 v208, v208, v16
    v_mul_f32 v209, v209, v17
    v_mfma_f32_16x16x32_bf16 v[212:215], a[52:55], a[192:195], v[212:215]
    v_mul_f32 v210, v210, v18
    v_mul_f32 v211, v211, v19
    v_mfma_f32_16x16x32_bf16 v[220:223], a[52:55], v[96:99], v[220:223]
    v_cvt_pk_bf16_f32 v211, v210, v211
    v_mfma_f32_16x16x32_bf16 v[220:223], a[76:79], v[100:103], v[220:223]
    buffer_store_dwordx4 v[202:205], v10, s[16:19], s37 offen offset:1024 sc1 nt
    v_mfma_f32_16x16x32_bf16 v[220:223], a[100:103], v[104:107], v[220:223]
    v_cvt_pk_bf16_f32 v210, v208, v209
    v_fma_f32 v212, v212, v44, v52
    v_mfma_f32_16x16x32_bf16 v[220:223], a[124:127], v[108:111], v[220:223]
    v_fma_f32 v213, v213, v45, v53
    v_fma_f32 v214, v214, v46, v54
    v_mfma_f32_16x16x32_bf16 v[220:223], a[148:151], v[112:115], v[220:223]
    v_fma_f32 v215, v215, v47, v55
    v_mfma_f32_16x16x32_bf16 v[220:223], a[172:175], v[116:119], v[220:223]
    v_exp_f32 v20, v212
    v_mfma_f32_16x16x32_bf16 v[220:223], a[180:183], a[236:239], v[220:223]
    v_exp_f32 v21, v213
    v_mfma_f32_16x16x32_bf16 v[220:223], a[156:159], a[232:235], v[220:223]
    v_exp_f32 v22, v214
    v_mfma_f32_16x16x32_bf16 v[220:223], a[132:135], a[228:231], v[220:223]
    v_exp_f32 v23, v215
    v_mfma_f32_16x16x32_bf16 v[220:223], a[108:111], a[224:227], v[220:223]
    v_fma_f32 v20, v20, s34, s34
    v_fma_f32 v21, v21, s34, s34
    v_mfma_f32_16x16x32_bf16 v[220:223], a[84:87], a[220:223], v[220:223]
    v_fma_f32 v22, v22, s34, s34
    v_fma_f32 v23, v23, s34, s34
    v_mfma_f32_16x16x32_bf16 v[220:223], a[60:63], a[216:219], v[220:223]
    s_waitcnt lgkmcnt(5)
    v_rcp_f32 v20, v20
    v_mfma_f32_16x16x32_bf16 v[220:223], a[68:71], v[64:67], v[220:223]
    s_waitcnt lgkmcnt(4)
    v_rcp_f32 v21, v21
    v_mfma_f32_16x16x32_bf16 v[220:223], a[92:95], v[68:71], v[220:223]
    s_waitcnt lgkmcnt(3)
    v_rcp_f32 v22, v22
    v_mfma_f32_16x16x32_bf16 v[220:223], a[116:119], v[72:75], v[220:223]
    s_waitcnt lgkmcnt(2)
    v_rcp_f32 v23, v23
    v_mfma_f32_16x16x32_bf16 v[220:223], a[140:143], v[76:79], v[220:223]
    s_waitcnt lgkmcnt(1)
    v_mul_f32 v212, v212, v20
    v_mul_f32 v213, v213, v21
    v_mfma_f32_16x16x32_bf16 v[220:223], a[164:167], v[80:83], v[220:223]
    s_waitcnt lgkmcnt(0)
    v_mul_f32 v214, v214, v22
    v_mul_f32 v215, v215, v23
    v_mfma_f32_16x16x32_bf16 v[220:223], a[188:191], v[84:87], v[220:223]
    v_cvt_pk_bf16_f32 v212, v212, v213
    v_mfma_f32_16x16x32_bf16 v[216:219], a[184:187], v[84:87], v[216:219]
    ds_read_b128 a[192:195], v12 offset:50176
    v_cvt_pk_bf16_f32 v213, v214, v215
    v_mfma_f32_16x16x32_bf16 v[216:219], a[160:163], v[80:83], v[216:219]
    ds_read_b128 a[196:199], v13 offset:50176
    v_mfma_f32_16x16x32_bf16 v[216:219], a[136:139], v[76:79], v[216:219]
    ds_read_b128 a[200:203], v12 offset:52224
    v_fma_f32 v220, v220, v44, v52
    v_mfma_f32_16x16x32_bf16 v[216:219], a[112:115], v[72:75], v[216:219]
    buffer_store_dwordx4 v[210:213], v10, s[16:19], s37 offen offset:2048 sc1 nt
    v_mfma_f32_16x16x32_bf16 v[216:219], a[88:91], v[68:71], v[216:219]
    ds_read_b128 a[204:207], v13 offset:52224
    v_fma_f32 v221, v221, v45, v53
    v_mfma_f32_16x16x32_bf16 v[216:219], a[64:67], v[64:67], v[216:219]
    ds_read_b128 a[208:211], v12 offset:54272
    v_fma_f32 v222, v222, v46, v54
    v_mfma_f32_16x16x32_bf16 v[216:219], a[56:59], a[216:219], v[216:219]
    ds_read_b128 a[212:215], v13 offset:54272
    v_fma_f32 v223, v223, v47, v55
    v_mfma_f32_16x16x32_bf16 v[216:219], a[80:83], a[220:223], v[216:219]
    v_exp_f32 v28, v220
    v_mfma_f32_16x16x32_bf16 v[216:219], a[104:107], a[224:227], v[216:219]
    v_exp_f32 v29, v221
    v_mfma_f32_16x16x32_bf16 v[216:219], a[128:131], a[228:231], v[216:219]
    v_exp_f32 v30, v222
    v_mfma_f32_16x16x32_bf16 v[216:219], a[152:155], a[232:235], v[216:219]
    v_exp_f32 v31, v223
    v_mfma_f32_16x16x32_bf16 v[216:219], a[176:179], a[236:239], v[216:219]
    v_fma_f32 v28, v28, s34, s34
    v_fma_f32 v29, v29, s34, s34
    v_mfma_f32_16x16x32_bf16 v[216:219], a[168:171], v[116:119], v[216:219]
    v_fma_f32 v30, v30, s34, s34
    v_fma_f32 v31, v31, s34, s34
    v_mfma_f32_16x16x32_bf16 v[216:219], a[144:147], v[112:115], v[216:219]
    v_rcp_f32 v28, v28
    v_mfma_f32_16x16x32_bf16 v[216:219], a[120:123], v[108:111], v[216:219]
    v_rcp_f32 v29, v29
    v_mfma_f32_16x16x32_bf16 v[216:219], a[96:99], v[104:107], v[216:219]
    v_rcp_f32 v30, v30
    v_mfma_f32_16x16x32_bf16 v[216:219], a[72:75], v[100:103], v[216:219]
    v_rcp_f32 v31, v31
    v_mfma_f32_16x16x32_bf16 v[216:219], a[48:51], v[96:99], v[216:219]
    v_mul_f32 v220, v220, v28
    v_mul_f32 v221, v221, v29
    v_mfma_f32_16x16x32_bf16 v[224:227], a[48:51], a[216:219], v[224:227]
    v_mul_f32 v222, v222, v30
    v_mul_f32 v223, v223, v31
    v_mfma_f32_16x16x32_bf16 v[224:227], a[72:75], a[220:223], v[224:227]
    v_cvt_pk_bf16_f32 v220, v220, v221
    v_mfma_f32_16x16x32_bf16 v[224:227], a[96:99], a[224:227], v[224:227]
    v_cvt_pk_bf16_f32 v221, v222, v223
    v_fma_f32 v216, v216, v40, v48
    v_mfma_f32_16x16x32_bf16 v[224:227], a[120:123], a[228:231], v[224:227]
    v_fma_f32 v217, v217, v41, v49
    v_fma_f32 v218, v218, v42, v50
    v_mfma_f32_16x16x32_bf16 v[224:227], a[144:147], a[232:235], v[224:227]
    v_fma_f32 v219, v219, v43, v51
    v_mfma_f32_16x16x32_bf16 v[224:227], a[168:171], a[236:239], v[224:227]
    v_exp_f32 v24, v216
    v_mfma_f32_16x16x32_bf16 v[224:227], a[176:179], v[84:87], v[224:227]
    v_exp_f32 v25, v217
    v_mfma_f32_16x16x32_bf16 v[224:227], a[152:155], v[80:83], v[224:227]
    v_exp_f32 v26, v218
    v_mfma_f32_16x16x32_bf16 v[224:227], a[128:131], v[76:79], v[224:227]
    v_exp_f32 v27, v219
    v_mfma_f32_16x16x32_bf16 v[224:227], a[104:107], v[72:75], v[224:227]
    v_fma_f32 v24, v24, s34, s34
    v_fma_f32 v25, v25, s34, s34
    v_mfma_f32_16x16x32_bf16 v[224:227], a[80:83], v[68:71], v[224:227]
    v_fma_f32 v26, v26, s34, s34
    v_fma_f32 v27, v27, s34, s34
    v_mfma_f32_16x16x32_bf16 v[224:227], a[56:59], v[64:67], v[224:227]
    s_waitcnt lgkmcnt(5)
    v_rcp_f32 v24, v24
    v_mfma_f32_16x16x32_bf16 v[224:227], a[64:67], a[192:195], v[224:227]
    s_waitcnt lgkmcnt(4)
    v_rcp_f32 v25, v25
    v_mfma_f32_16x16x32_bf16 v[224:227], a[88:91], a[196:199], v[224:227]
    s_waitcnt lgkmcnt(3)
    v_rcp_f32 v26, v26
    v_mfma_f32_16x16x32_bf16 v[224:227], a[112:115], a[200:203], v[224:227]
    s_waitcnt lgkmcnt(2)
    v_rcp_f32 v27, v27
    v_mfma_f32_16x16x32_bf16 v[224:227], a[136:139], a[204:207], v[224:227]
    s_waitcnt lgkmcnt(1)
    v_mul_f32 v216, v216, v24
    v_mul_f32 v217, v217, v25
    v_mfma_f32_16x16x32_bf16 v[224:227], a[160:163], a[208:211], v[224:227]
    s_waitcnt lgkmcnt(0)
    v_mul_f32 v218, v218, v26
    v_mul_f32 v219, v219, v27
    v_mfma_f32_16x16x32_bf16 v[224:227], a[184:187], a[212:215], v[224:227]
    v_cvt_pk_bf16_f32 v219, v218, v219
    v_mfma_f32_16x16x32_bf16 v[228:231], a[188:191], a[212:215], v[228:231]
    ds_read_b128 v[96:99], v14 offset:0
    v_cvt_pk_bf16_f32 v218, v216, v217
    v_mfma_f32_16x16x32_bf16 v[228:231], a[164:167], a[208:211], v[228:231]
    buffer_store_dwordx4 v[218:221], v10, s[16:19], s37 offen offset:3072 sc1 nt
    v_mfma_f32_16x16x32_bf16 v[228:231], a[140:143], a[204:207], v[228:231]
    ds_read_b128 v[100:103], v15 offset:0
    v_fma_f32 v224, v224, v40, v48
    v_mfma_f32_16x16x32_bf16 v[228:231], a[116:119], a[200:203], v[228:231]
    ds_read_b128 v[104:107], v14 offset:2048
    v_fma_f32 v225, v225, v41, v49
    v_mfma_f32_16x16x32_bf16 v[228:231], a[92:95], a[196:199], v[228:231]
    ds_read_b128 v[108:111], v15 offset:2048
    v_fma_f32 v226, v226, v42, v50
    v_mfma_f32_16x16x32_bf16 v[228:231], a[68:71], a[192:195], v[228:231]
    ds_read_b128 v[112:115], v14 offset:4096
    v_fma_f32 v227, v227, v43, v51
    v_mfma_f32_16x16x32_bf16 v[228:231], a[60:63], v[64:67], v[228:231]
    ds_read_b128 v[116:119], v15 offset:4096
    v_mfma_f32_16x16x32_bf16 v[228:231], a[84:87], v[68:71], v[228:231]
    v_exp_f32 v16, v224
    v_mfma_f32_16x16x32_bf16 v[228:231], a[108:111], v[72:75], v[228:231]
    v_exp_f32 v17, v225
    v_mfma_f32_16x16x32_bf16 v[228:231], a[132:135], v[76:79], v[228:231]
    v_exp_f32 v18, v226
    v_mfma_f32_16x16x32_bf16 v[228:231], a[156:159], v[80:83], v[228:231]
    v_exp_f32 v19, v227
    v_mfma_f32_16x16x32_bf16 v[228:231], a[180:183], v[84:87], v[228:231]
    v_fma_f32 v16, v16, s34, s34
    v_fma_f32 v17, v17, s34, s34
    v_mfma_f32_16x16x32_bf16 v[228:231], a[172:175], a[236:239], v[228:231]
    v_fma_f32 v18, v18, s34, s34
    v_fma_f32 v19, v19, s34, s34
    v_mfma_f32_16x16x32_bf16 v[228:231], a[148:151], a[232:235], v[228:231]
    v_rcp_f32 v16, v16
    v_mfma_f32_16x16x32_bf16 v[228:231], a[124:127], a[228:231], v[228:231]
    v_rcp_f32 v17, v17
    v_mfma_f32_16x16x32_bf16 v[228:231], a[100:103], a[224:227], v[228:231]
    v_rcp_f32 v18, v18
    v_mfma_f32_16x16x32_bf16 v[228:231], a[76:79], a[220:223], v[228:231]
    v_rcp_f32 v19, v19
    v_mfma_f32_16x16x32_bf16 v[228:231], a[52:55], a[216:219], v[228:231]
    v_mul_f32 v224, v224, v16
    v_mul_f32 v225, v225, v17
    v_mfma_f32_16x16x32_bf16 v[236:239], a[52:55], v[64:67], v[236:239]
    v_mul_f32 v226, v226, v18
    v_mul_f32 v227, v227, v19
    v_mfma_f32_16x16x32_bf16 v[236:239], a[76:79], v[68:71], v[236:239]
    v_cvt_pk_bf16_f32 v227, v226, v227
    v_mfma_f32_16x16x32_bf16 v[236:239], a[100:103], v[72:75], v[236:239]
    v_cvt_pk_bf16_f32 v226, v224, v225
    v_fma_f32 v228, v228, v44, v52
    v_mfma_f32_16x16x32_bf16 v[236:239], a[124:127], v[76:79], v[236:239]
    v_fma_f32 v229, v229, v45, v53
L_stub5:
    s_cbranch_vccnz L_back1
    v_fma_f32 v230, v230, v46, v54
    v_mfma_f32_16x16x32_bf16 v[236:239], a[148:151], v[80:83], v[236:239]
    v_fma_f32 v231, v231, v47, v55
    v_mfma_f32_16x16x32_bf16 v[236:239], a[172:175], v[84:87], v[236:239]
    v_exp_f32 v20, v228
    v_mfma_f32_16x16x32_bf16 v[236:239], a[180:183], a[212:215], v[236:239]
    v_exp_f32 v21, v229
    v_mfma_f32_16x16x32_bf16 v[236:239], a[156:159], a[208:211], v[236:239]
    v_exp_f32 v22, v230
    v_mfma_f32_16x16x32_bf16 v[236:239], a[132:135], a[204:207], v[236:239]
    v_exp_f32 v23, v231
    v_mfma_f32_16x16x32_bf16 v[236:239], a[108:111], a[200:203], v[236:239]
    v_fma_f32 v20, v20, s34, s34
    v_fma_f32 v21, v21, s34, s34
    v_mfma_f32_16x16x32_bf16 v[236:239], a[84:87], a[196:199], v[236:239]
    v_fma_f32 v22, v22, s34, s34
    v_fma_f32 v23, v23, s34, s34
    v_mfma_f32_16x16x32_bf16 v[236:239], a[60:63], a[192:195], v[236:239]
    s_waitcnt lgkmcnt(5)
    v_rcp_f32 v20, v20
    v_mfma_f32_16x16x32_bf16 v[236:239], a[68:71], v[96:99], v[236:239]
    s_waitcnt lgkmcnt(4)
    ds_read_b128 a[236:239], v15 offset:5120
    v_mul_f32 v228, v228, v20
    v_mfma_f32_16x16x32_bf16 v[236:239], a[92:95], v[100:103], v[236:239]
    s_waitcnt lgkmcnt(4)
    ds_read_b128 a[232:235], v14 offset:5120
    v_mfma_f32_16x16x32_bf16 v[236:239], a[116:119], v[104:107], v[236:239]
    s_waitcnt lgkmcnt(4)
    ds_read_b128 a[228:231], v15 offset:3072
    v_mfma_f32_16x16x32_bf16 v[236:239], a[140:143], v[108:111], v[236:239]
    s_waitcnt lgkmcnt(4)
    ds_read_b128 a[224:227], v14 offset:3072
    v_mfma_f32_16x16x32_bf16 v[236:239], a[164:167], v[112:115], v[236:239]
    s_waitcnt lgkmcnt(4)
    ds_read_b128 a[220:223], v15 offset:1024
    v_mfma_f32_16x16x32_bf16 v[236:239], a[188:191], v[116:119], v[236:239]
    ds_read_b128 a[216:219], v14 offset:1024
    v_mfma_f32_16x16x32_bf16 v[232:235], a[184:187], v[116:119], v[232:235]
    v_rcp_f32 v21, v21
    v_mfma_f32_16x16x32_bf16 v[232:235], a[160:163], v[112:115], v[232:235]
    v_rcp_f32 v22, v22
    v_mfma_f32_16x16x32_bf16 v[232:235], a[136:139], v[108:111], v[232:235]
    v_rcp_f32 v23, v23
    v_mfma_f32_16x16x32_bf16 v[232:235], a[112:115], v[104:107], v[232:235]
    v_mul_f32 v229, v229, v21
    v_mul_f32 v230, v230, v22
    v_mfma_f32_16x16x32_bf16 v[232:235], a[88:91], v[100:103], v[232:235]
    v_mul_f32 v231, v231, v23
    v_cvt_pk_bf16_f32 v228, v228, v229
    v_mfma_f32_16x16x32_bf16 v[232:235], a[64:67], v[96:99], v[232:235]
    v_cvt_pk_bf16_f32 v229, v230, v231
    v_fma_f32 v236, v236, v44, v52
    v_mfma_f32_16x16x32_bf16 v[232:235], a[56:59], a[192:195], v[232:235]
    buffer_store_dwordx4 v[226:229], v10, s[16:19], s38 offen offset:0 sc1 nt
    v_mfma_f32_16x16x32_bf16 v[232:235], a[80:83], a[196:199], v[232:235]
    v_fma_f32 v237, v237, v45, v53
    v_fma_f32 v238, v238, v46, v54
    v_mfma_f32_16x16x32_bf16 v[232:235], a[104:107], a[200:203], v[232:235]
    v_fma_f32 v239, v239, v47, v55
    v_mfma_f32_16x16x32_bf16 v[232:235], a[128:131], a[204:207], v[232:235]
    v_exp_f32 v28, v236
    v_mfma_f32_16x16x32_bf16 v[232:235], a[152:155], a[208:211], v[232:235]
    v_exp_f32 v29, v237
    v_mfma_f32_16x16x32_bf16 v[232:235], a[176:179], a[212:215], v[232:235]
    v_exp_f32 v30, v238
    v_mfma_f32_16x16x32_bf16 v[232:235], a[168:171], v[84:87], v[232:235]
    v_exp_f32 v31, v239
    v_mfma_f32_16x16x32_bf16 v[232:235], a[144:147], v[80:83], v[232:235]
    v_fma_f32 v28, v28, s34, s34
    v_fma_f32 v29, v29, s34, s34
    v_mfma_f32_16x16x32_bf16 v[232:235], a[120:123], v[76:79], v[232:235]
    v_fma_f32 v30, v30, s34, s34
    v_fma_f32 v31, v31, s34, s34
    v_mfma_f32_16x16x32_bf16 v[232:235], a[96:99], v[72:75], v[232:235]
    v_rcp_f32 v28, v28
    v_mfma_f32_16x16x32_bf16 v[232:235], a[72:75], v[68:71], v[232:235]
    v_rcp_f32 v29, v29
    v_mfma_f32_16x16x32_bf16 v[232:235], a[48:51], v[64:67], v[232:235]
    v_rcp_f32 v30, v30
    v_mfma_f32_16x16x32_bf16 v[248:251], a[48:51], v[96:99], v[248:251]
    v_rcp_f32 v31, v31
    v_mfma_f32_16x16x32_bf16 v[248:251], a[72:75], v[100:103], v[248:251]
    v_mul_f32 v236, v236, v28
    v_mul_f32 v237, v237, v29
    v_mfma_f32_16x16x32_bf16 v[248:251], a[96:99], v[104:107], v[248:251]
    v_mul_f32 v238, v238, v30
    v_mul_f32 v239, v239, v31
    v_mfma_f32_16x16x32_bf16 v[248:251], a[120:123], v[108:111], v[248:251]
    v_cvt_pk_bf16_f32 v236, v236, v237
    v_fma_f32 v232, v232, v40, v48
    v_mfma_f32_16x16x32_bf16 v[248:251], a[144:147], v[112:115], v[248:251]
    v_cvt_pk_bf16_f32 v237, v238, v239
    v_fma_f32 v233, v233, v41, v49
    v_mfma_f32_16x16x32_bf16 v[248:251], a[168:171], v[116:119], v[248:251]
    s_waitcnt lgkmcnt(5)
    v_fma_f32 v234, v234, v42, v50
    v_fma_f32 v235, v235, v43, v51
    v_mfma_f32_16x16x32_bf16 v[248:251], a[176:179], a[236:239], v[248:251]
    s_waitcnt lgkmcnt(4)
    v_exp_f32 v24, v232
    v_mfma_f32_16x16x32_bf16 v[248:251], a[152:155], a[232:235], v[248:251]
    s_waitcnt lgkmcnt(3)
    v_exp_f32 v25, v233
    v_mfma_f32_16x16x32_bf16 v[248:251], a[128:131], a[228:231], v[248:251]
    s_waitcnt lgkmcnt(2)
    v_exp_f32 v26, v234
    v_mfma_f32_16x16x32_bf16 v[248:251], a[104:107], a[224:227], v[248:251]
    s_waitcnt lgkmcnt(1)
    v_exp_f32 v27, v235
    v_mfma_f32_16x16x32_bf16 v[248:251], a[80:83], a[220:223], v[248:251]
    s_waitcnt lgkmcnt(0)
    v_fma_f32 v24, v24, s34, s34
    v_fma_f32 v25, v25, s34, s34
    v_mfma_f32_16x16x32_bf16 v[248:251], a[56:59], a[216:219], v[248:251]
    v_fma_f32 v26, v26, s34, s34
    v_fma_f32 v27, v27, s34, s34
    v_mfma_f32_16x16x32_bf16 v[252:255], a[60:63], a[216:219], v[252:255]
    v_rcp_f32 v24, v24
    v_mfma_f32_16x16x32_bf16 v[252:255], a[84:87], a[220:223], v[252:255]
    v_rcp_f32 v25, v25
    v_mfma_f32_16x16x32_bf16 v[252:255], a[108:111], a[224:227], v[252:255]
    v_rcp_f32 v26, v26
    v_mfma_f32_16x16x32_bf16 v[252:255], a[132:135], a[228:231], v[252:255]
    v_rcp_f32 v27, v27
    v_mfma_f32_16x16x32_bf16 v[252:255], a[156:159], a[232:235], v[252:255]
    v_mul_f32 v232, v232, v24
    v_mul_f32 v233, v233, v25
    v_mfma_f32_16x16x32_bf16 v[252:255], a[180:183], a[236:239], v[252:255]
    v_mul_f32 v234, v234, v26
    v_mul_f32 v235, v235, v27
    v_mfma_f32_16x16x32_bf16 v[252:255], a[172:175], v[116:119], v[252:255]
    v_cvt_pk_bf16_f32 v235, v234, v235
    v_fma_f32 v248, v248, v40, v48
    v_mfma_f32_16x16x32_bf16 v[252:255], a[148:151], v[112:115], v[252:255]
    v_cvt_pk_bf16_f32 v234, v232, v233
    v_fma_f32 v249, v249, v41, v49
    v_mfma_f32_16x16x32_bf16 v[252:255], a[124:127], v[108:111], v[252:255]
    buffer_store_dwordx4 v[234:237], v10, s[16:19], s38 offen offset:1024 sc1 nt
    v_mfma_f32_16x16x32_bf16 v[252:255], a[100:103], v[104:107], v[252:255]
    v_fma_f32 v250, v250, v42, v50
    v_fma_f32 v251, v251, v43, v51
    v_mfma_f32_16x16x32_bf16 v[252:255], a[76:79], v[100:103], v[252:255]
    v_exp_f32 v16, v248
    v_mfma_f32_16x16x32_bf16 v[252:255], a[52:55], v[96:99], v[252:255]
    v_exp_f32 v17, v249
    v_mfma_f32_16x16x32_bf16 v[244:247], a[52:55], a[192:195], v[244:247]
    v_exp_f32 v18, v250
    v_mfma_f32_16x16x32_bf16 v[244:247], a[76:79], a[196:199], v[244:247]
    v_exp_f32 v19, v251
    v_mfma_f32_16x16x32_bf16 v[244:247], a[100:103], a[200:203], v[244:247]
    v_fma_f32 v16, v16, s34, s34
    v_fma_f32 v17, v17, s34, s34
    v_mfma_f32_16x16x32_bf16 v[244:247], a[124:127], a[204:207], v[244:247]
    v_fma_f32 v18, v18, s34, s34
    v_fma_f32 v19, v19, s34, s34
    v_mfma_f32_16x16x32_bf16 v[244:247], a[148:151], a[208:211], v[244:247]
    v_rcp_f32 v16, v16
    v_mfma_f32_16x16x32_bf16 v[244:247], a[172:175], a[212:215], v[244:247]
    v_rcp_f32 v17, v17
    v_mfma_f32_16x16x32_bf16 v[244:247], a[180:183], v[116:119], v[244:247]
    v_rcp_f32 v18, v18
    v_mfma_f32_16x16x32_bf16 v[244:247], a[156:159], v[112:115], v[244:247]
    v_rcp_f32 v19, v19
    v_mfma_f32_16x16x32_bf16 v[244:247], a[132:135], v[108:111], v[244:247]
    v_mul_f32 v248, v248, v16
    v_mul_f32 v249, v249, v17
    v_mfma_f32_16x16x32_bf16 v[244:247], a[108:111], v[104:107], v[244:247]
    v_mul_f32 v250, v250, v18
    v_mul_f32 v251, v251, v19
    v_mfma_f32_16x16x32_bf16 v[244:247], a[84:87], v[100:103], v[244:247]
    v_cvt_pk_bf16_f32 v251, v250, v251
    v_fma_f32 v252, v252, v44, v52
    v_mfma_f32_16x16x32_bf16 v[244:247], a[60:63], v[96:99], v[244:247]
    v_cvt_pk_bf16_f32 v250, v248, v249
    v_fma_f32 v253, v253, v45, v53
    v_mfma_f32_16x16x32_bf16 v[244:247], a[68:71], a[216:219], v[244:247]
    v_fma_f32 v254, v254, v46, v54
    v_fma_f32 v255, v255, v47, v55
    v_mfma_f32_16x16x32_bf16 v[244:247], a[92:95], a[220:223], v[244:247]
    v_exp_f32 v20, v252
    v_mfma_f32_16x16x32_bf16 v[244:247], a[116:119], a[224:227], v[244:247]
    v_exp_f32 v21, v253
    v_mfma_f32_16x16x32_bf16 v[244:247], a[140:143], a[228:231], v[244:247]
    v_exp_f32 v22, v254
    v_mfma_f32_16x16x32_bf16 v[244:247], a[164:167], a[232:235], v[244:247]
    v_exp_f32 v23, v255
    v_mfma_f32_16x16x32_bf16 v[244:247], a[188:191], a[236:239], v[244:247]
    v_fma_f32 v20, v20, s34, s34
    v_fma_f32 v21, v21, s34, s34
    v_mfma_f32_16x16x32_bf16 v[240:243], a[184:187], a[236:239], v[240:243]
    v_fma_f32 v22, v22, s34, s34
    v_fma_f32 v23, v23, s34, s34
    v_mfma_f32_16x16x32_bf16 v[240:243], a[160:163], a[232:235], v[240:243]
    v_rcp_f32 v20, v20
    v_mfma_f32_16x16x32_bf16 v[240:243], a[136:139], a[228:231], v[240:243]
    v_rcp_f32 v21, v21
    v_mfma_f32_16x16x32_bf16 v[240:243], a[112:115], a[224:227], v[240:243]
    v_rcp_f32 v22, v22
    v_mfma_f32_16x16x32_bf16 v[240:243], a[88:91], a[220:223], v[240:243]
    v_rcp_f32 v23, v23
    v_mfma_f32_16x16x32_bf16 v[240:243], a[64:67], a[216:219], v[240:243]
    v_mul_f32 v252, v252, v20
    v_mul_f32 v253, v253, v21
    v_mfma_f32_16x16x32_bf16 v[240:243], a[56:59], v[96:99], v[240:243]
    v_mul_f32 v254, v254, v22
    v_mul_f32 v255, v255, v23
    v_mfma_f32_16x16x32_bf16 v[240:243], a[80:83], v[100:103], v[240:243]
    v_cvt_pk_bf16_f32 v252, v252, v253
    v_fma_f32 v244, v244, v44, v52
    v_mfma_f32_16x16x32_bf16 v[240:243], a[104:107], v[104:107], v[240:243]
    v_cvt_pk_bf16_f32 v253, v254, v255
    v_fma_f32 v245, v245, v45, v53
    v_mfma_f32_16x16x32_bf16 v[240:243], a[128:131], v[108:111], v[240:243]
    buffer_store_dwordx4 v[250:253], v10, s[16:19], s38 offen offset:3072 sc1 nt
    v_mfma_f32_16x16x32_bf16 v[240:243], a[152:155], v[112:115], v[240:243]
    v_fma_f32 v246, v246, v46, v54
    v_fma_f32 v247, v247, v47, v55
    v_mfma_f32_16x16x32_bf16 v[240:243], a[176:179], v[116:119], v[240:243]
    v_exp_f32 v28, v244
    v_mfma_f32_16x16x32_bf16 v[240:243], a[168:171], a[212:215], v[240:243]
    v_exp_f32 v29, v245
    v_mfma_f32_16x16x32_bf16 v[240:243], a[144:147], a[208:211], v[240:243]
    v_exp_f32 v30, v246
    v_mfma_f32_16x16x32_bf16 v[240:243], a[120:123], a[204:207], v[240:243]
    v_exp_f32 v31, v247
    v_mfma_f32_16x16x32_bf16 v[240:243], a[96:99], a[200:203], v[240:243]
    v_fma_f32 v28, v28, s34, s34
    v_fma_f32 v29, v29, s34, s34
    v_mfma_f32_16x16x32_bf16 v[240:243], a[72:75], a[196:199], v[240:243]
    v_fma_f32 v30, v30, s34, s34
    v_fma_f32 v31, v31, s34, s34
    v_mfma_f32_16x16x32_bf16 v[240:243], a[48:51], a[192:195], v[240:243]
    v_rcp_f32 v28, v28
    v_rcp_f32 v29, v29
    v_rcp_f32 v30, v30
    v_rcp_f32 v31, v31
    v_pk_mul_f32 v[244:245], v[244:245], v[28:29]
    v_pk_mul_f32 v[246:247], v[246:247], v[30:31]
    v_cvt_pk_bf16_f32 v244, v244, v245
    v_cvt_pk_bf16_f32 v245, v246, v247
    v_pk_fma_f32 v[240:241], v[240:241], v[40:41], v[48:49]
    v_pk_fma_f32 v[242:243], v[242:243], v[42:43], v[50:51]
    v_exp_f32 v24, v240
    v_exp_f32 v25, v241
    v_exp_f32 v26, v242
    v_exp_f32 v27, v243
    v_pk_fma_f32 v[24:25], v[24:25], s[34:35], s[34:35]
    v_pk_fma_f32 v[26:27], v[26:27], s[34:35], s[34:35]
    v_rcp_f32 v24, v24
    v_rcp_f32 v25, v25
    v_rcp_f32 v26, v26
    v_rcp_f32 v27, v27
    v_pk_mul_f32 v[240:241], v[240:241], v[24:25]
    v_pk_mul_f32 v[242:243], v[242:243], v[26:27]
    v_cvt_pk_bf16_f32 v243, v242, v243
    v_cvt_pk_bf16_f32 v242, v240, v241
    buffer_store_dwordx4 v[242:245], v10, s[16:19], s38 offen offset:2048 sc1
L_end:
    s_endpgm
    .fill 2048, 4, 0xbf810000
.section .rodata,"a"
.p2align 6
.amdhsa_kernel standalone__batchnorm__sampling_kernel
  .amdhsa_next_free_vgpr 496
  .amdhsa_next_free_sgpr 102
  .amdhsa_accum_offset 256
  .amdhsa_group_segment_fixed_size 0
  .amdhsa_kernarg_size 72
  .amdhsa_user_sgpr_count 2
  .amdhsa_user_sgpr_kernarg_segment_ptr 1
  .amdhsa_system_sgpr_workgroup_id_x 1
  .amdhsa_float_denorm_mode_32 3
.end_amdhsa_kernel
```
